```python
import torch

def _softmax(x, axis=-1):
    return torch.softmax(x, dim=axis)
def _gelu(x):
    return torch.nn.functional.gelu(x, approximate="tanh")
def _silu(x):
    return torch.nn.functional.silu(x)
def _sigmoid(x):
    return torch.sigmoid(x)
def _layernorm(x, axis=-1, eps=1e-5):
    m = x.mean(dim=axis, keepdim=True)
    v = x.var(dim=axis, keepdim=True, unbiased=False)
    return (x - m) / torch.sqrt(v + eps)
def _scatter_add(tgt, idx, src, axis=0):
    return tgt.clone().index_add_(axis, idx, src)
def _segment_sum(src, seg, n):
    out = torch.zeros((n,) + src.shape[1:], dtype=src.dtype)
    return out.index_add_(0, seg, src)
def _pad(x, pw):
    flat = tuple(v for pair in reversed(pw) for v in pair)
    return torch.nn.functional.pad(x, flat)

kernel_name = 'standalone__adm_resblock__diffusion'

def setup_inputs():

    _w = (lambda a: (lambda t: t.to(torch.bfloat16) if t.is_floating_point() else t)(torch.as_tensor(a)))
    B, C, HW, E = 2, 128, 128, 1152
    sc = (9.0 * C) ** -0.5
    return {
        "x": _w((lambda *s: torch.randn(*s, dtype=torch.bfloat16) * 0.05)(B, C, HW, HW)),
        "t_emb": _w((lambda *s: torch.randn(*s, dtype=torch.bfloat16) * 0.4)(B, E)),
        "g1": _w(1.0 + 0.1 * (lambda *s: torch.randn(*s, dtype=torch.bfloat16) * 0.4)(C)),
        "be1": _w(0.1 * (lambda *s: torch.randn(*s, dtype=torch.bfloat16) * 0.4)(C)),
        "w1": _w((lambda *s: torch.randn(*s, dtype=torch.bfloat16) * 0.4)(C, C, 3, 3) * sc),
        "w_emb": _w((lambda *s: torch.randn(*s, dtype=torch.bfloat16) * 0.4)(E, C) * (E ** -0.5)),
        "g2": _w(1.0 + 0.1 * (lambda *s: torch.randn(*s, dtype=torch.bfloat16) * 0.4)(C)),
        "be2": _w(0.1 * (lambda *s: torch.randn(*s, dtype=torch.bfloat16) * 0.4)(C)),
        "w2": _w((lambda *s: torch.randn(*s, dtype=torch.bfloat16) * 0.4)(C, C, 3, 3) * sc),
    }

def reference(x, t_emb, g1, be1, w1, w_emb, g2, be2, w2):
    B, C, H, W = x.shape
    G, eps = 4, 1e-5
    def gn(z, gamma, beta):
        zr = z.reshape(B, G, (C // G) * H * W)
        mu = zr.mean(-1).reshape(B, G, 1)
        var = ((zr - mu) ** 2).mean(-1).reshape(B, G, 1)
        zn = ((zr - mu) / torch.sqrt(var + eps)).reshape(B, C, H, W)
        return zn * gamma.reshape(1, C, 1, 1) + beta.reshape(1, C, 1, 1)
    def conv3(z, w):
        zp = _pad(z, ((0, 0), (0, 0), (1, 1), (1, 1)))
        taps = [torch.einsum("bchw,oc->bohw", zp[:, :, i:i+H, j:j+W], w[:, :, i, j]) for i in range(3) for j in range(3)]
        out = taps[0]
        for t in taps[1:]:
            out = out + t
        return out
    h = conv3(_silu(gn(x, g1, be1)), w1)
    emb = _silu(t_emb) @ w_emb
    h = h + emb.reshape(B, C, 1, 1)
    h = conv3(_silu(gn(h, g2, be2)), w2)
    return x + h
```

```asm
; @launch grid=(256,1,1) block=(256,1,1) lds=131840
.amdgcn_target "amdgcn-amd-amdhsa--gfx950"
.text
.globl standalone__adm_resblock__diffusion_kernel
.p2align 12
.fill 832, 4, 0xbf800000
.p2align 8
.type standalone__adm_resblock__diffusion_kernel,@function
standalone__adm_resblock__diffusion_kernel:
    s_cmp_ge_u32 s2, 256
    s_cbranch_scc1 L_end
    s_load_dwordx16 s[4:19], s[0:1], 0
    s_load_dwordx8 s[20:27], s[0:1], 64
    s_memrealtime s[96:97]
    s_getpc_b64 s[52:53]
L_pf_here:
    s_bfe_u32 s50, s2, 0x20003
    s_mul_i32 s50, s50, 12288
    v_mov_b32 v31, s53
    v_mad_u32_u24 v30, v0, 48, s50
    v_min_u32 v30, L_end-L_pf_here, v30
    v_add_co_u32 v30, vcc, s52, v30
    s_nop 1
    v_addc_co_u32 v31, vcc, 0, v31, vcc
    global_load_dword a255, v[30:31], off
    v_lshrrev_b32 v20, 6, v0
    v_and_b32 v1, 63, v0
    v_readfirstlane_b32 s40, v20
    v_mov_b32 v22, -1
    v_mov_b32 v23, -1
    v_mov_b32 v21, 131264
    s_and_b32 s50, s2, 7
    s_lshr_b32 s51, s2, 3
    s_lshr_b32 s41, s50, 2
    s_and_b32 s50, s50, 3
    s_lshl_b32 s50, s50, 3
    s_lshr_b32 s52, s51, 2
    s_add_u32 s42, s50, s52
    s_and_b32 s43, s51, 3
    s_lshl_b32 s44, s42, 2
    s_lshl_b32 s45, s43, 6
    v_lshlrev_b32 v2, 4, v1
    s_mov_b32 s30, 0x800000
    s_mov_b32 s31, 0x20000
    s_mov_b32 s34, 16777216
    s_mov_b32 s35, 0x20000
    ds_write_b64 v21, v[22:23]
    ds_write_b64 v21, v[22:23] offset:8
    ds_write_b64 v21, v[22:23] offset:16
    s_cmp_eq_u32 s40, 2
    s_cbranch_scc1 L_segW
    s_cmp_eq_u32 s40, 3
    s_cbranch_scc1 L_segD
    s_lshl_b32 s50, s41, 22
    s_lshl_b32 s51, s43, 20
    s_add_u32 s50, s50, s51
    s_lshl_b32 s51, s40, 19
    s_add_u32 s50, s50, s51
    s_lshl_b32 s51, s44, 8
    s_add_u32 s50, s50, s51
    s_waitcnt lgkmcnt(0)
    s_mov_b32 s28, s4
    s_mov_b32 s29, s5
    s_mov_b32 s32, s26
    s_mov_b32 s33, s27
    buffer_load_dwordx4 v[64:67], v2, s[28:31], s50 offen
    s_add_u32 s50, s50, 32768
    buffer_load_dwordx4 v[68:71], v2, s[28:31], s50 offen
    s_add_u32 s50, s50, 32768
    buffer_load_dwordx4 v[72:75], v2, s[28:31], s50 offen
    s_add_u32 s50, s50, 32768
    buffer_load_dwordx4 v[76:79], v2, s[28:31], s50 offen
    s_add_u32 s50, s50, 32768
    buffer_load_dwordx4 v[80:83], v2, s[28:31], s50 offen
    s_add_u32 s50, s50, 32768
    buffer_load_dwordx4 v[84:87], v2, s[28:31], s50 offen
    s_add_u32 s50, s50, 32768
    buffer_load_dwordx4 v[88:91], v2, s[28:31], s50 offen
    s_add_u32 s50, s50, 32768
    buffer_load_dwordx4 v[92:95], v2, s[28:31], s50 offen
    s_add_u32 s50, s50, 32768
    buffer_load_dwordx4 v[96:99], v2, s[28:31], s50 offen
    s_add_u32 s50, s50, 32768
    buffer_load_dwordx4 v[100:103], v2, s[28:31], s50 offen
    s_add_u32 s50, s50, 32768
    buffer_load_dwordx4 v[104:107], v2, s[28:31], s50 offen
    s_add_u32 s50, s50, 32768
    buffer_load_dwordx4 v[108:111], v2, s[28:31], s50 offen
    s_add_u32 s50, s50, 32768
    buffer_load_dwordx4 v[112:115], v2, s[28:31], s50 offen
    s_add_u32 s50, s50, 32768
    buffer_load_dwordx4 v[116:119], v2, s[28:31], s50 offen
    s_add_u32 s50, s50, 32768
    buffer_load_dwordx4 v[120:123], v2, s[28:31], s50 offen
    s_add_u32 s50, s50, 32768
    buffer_load_dwordx4 v[124:127], v2, s[28:31], s50 offen
    s_barrier
    s_branch L_segA
L_segW:
    s_lshr_b32 s50, s2, 7
    s_and_b32 s51, s2, 127
    s_lshr_b32 s52, s51, 3
    s_and_b32 s53, s51, 7
    s_mul_i32 s54, s53, 36864
    s_mul_i32 s55, s52, 144
    s_add_u32 s54, s54, s55
    v_mul_u32_u24 v36, 2304, v1
    v_add_u32 v36, s54, v36
    s_lshr_b32 s54, s52, 2
    s_lshr_b32 s55, s52, 1
    s_and_b32 s55, s55, 1
    s_and_b32 s56, s52, 1
    s_and_b32 s57, s52, 3
    s_lshr_b32 s60, s52, 3
    s_lshr_b32 s61, s52, 2
    s_and_b32 s61, s61, 1
    s_cmp_eq_u32 s50, 0
    s_cselect_b32 s54, s54, s57
    s_cselect_b32 s55, s55, s60
    s_cselect_b32 s56, s56, s61
    s_lshl_b32 s54, s54, 1
    s_add_u32 s54, s54, s55
    s_mul_i32 s54, s54, 9216
    s_mul_i32 s55, s50, 294912
    s_add_u32 s54, s54, s55
    s_lshr_b32 s55, s53, 1
    s_mul_i32 s55, s55, 73728
    s_add_u32 s54, s54, s55
    s_and_b32 s55, s53, 1
    s_lshl_b32 s55, s55, 8
    s_add_u32 s54, s54, s55
    s_lshl_b32 s56, s56, 9
    s_add_u32 s72, s54, s56
    s_add_u32 s73, s72, 4096
    s_add_u32 s74, s72, 8192
    s_mov_b32 s75, 0x07060100
    s_mov_b32 s76, 0x05040302
    s_waitcnt lgkmcnt(0)
    s_mov_b32 s28, s4
    s_mov_b32 s29, s5
    s_mov_b32 s32, s26
    s_mov_b32 s33, s27
    v_mov_b32 v25, 0
    s_cmp_lg_u32 s2, 0
    s_cbranch_scc1 L_nonce_skip
    s_or_b32 s61, s96, 1
    s_and_b32 s61, s61, 0x7fffffff
    v_mov_b32 v26, s61
    s_mov_b64 exec, 1
    global_store_dword v25, v26, s[24:25] offset:192 sc1
    s_mov_b64 exec, -1
    s_nop 0
L_nonce_skip:
    v_mov_b32 v24, 0
    s_cmp_lt_u32 s2, 128
    s_cbranch_scc1 L_nonce_ne
    global_load_dword v24, v25, s[24:25] offset:192 sc1
L_nonce_ne:
    s_cmp_eq_u32 s50, 0
    s_cselect_b32 s58, s12, s20
    s_cselect_b32 s59, s13, s21
    s_mov_b64 exec, 0xffff
    global_load_dwordx4 v[128:131], v36, s[58:59] offset:0
    global_load_dwordx4 v[132:135], v36, s[58:59] offset:16
    global_load_dwordx4 v[136:139], v36, s[58:59] offset:32
    global_load_dwordx4 v[140:143], v36, s[58:59] offset:48
    global_load_dwordx4 v[144:147], v36, s[58:59] offset:64
    global_load_dwordx4 v[148:151], v36, s[58:59] offset:80
    global_load_dwordx4 v[152:155], v36, s[58:59] offset:96
    global_load_dwordx4 v[156:159], v36, s[58:59] offset:112
    global_load_dwordx4 v[160:163], v36, s[58:59] offset:128
    s_mov_b64 exec, -1
    s_barrier
    s_branch L_w2rest
L_segD:
    s_sub_i32 s53, s45, 16
    s_movk_i32 s54, 240
    v_add_u32 v30, 0, v1
    v_mul_u32_u24 v31, 171, v30
    v_lshrrev_b32 v31, 10, v31
    v_mul_u32_u24 v32, 6, v31
    v_sub_u32 v32, v30, v32
    v_lshl_add_u32 v32, v32, 4, s53
    v_med3_i32 v32, v32, 0, s54
    v_lshl_add_u32 v164, v31, 15, v32
    v_add_u32 v30, 64, v1
    v_mul_u32_u24 v31, 171, v30
    v_lshrrev_b32 v31, 10, v31
    v_mul_u32_u24 v32, 6, v31
    v_sub_u32 v32, v30, v32
    v_lshl_add_u32 v32, v32, 4, s53
    v_med3_i32 v32, v32, 0, s54
    v_lshl_add_u32 v165, v31, 15, v32
    v_add_u32 v30, 128, v1
    v_mul_u32_u24 v31, 171, v30
    v_lshrrev_b32 v31, 10, v31
    v_mul_u32_u24 v32, 6, v31
    v_sub_u32 v32, v30, v32
    v_lshl_add_u32 v32, v32, 4, s53
    v_med3_i32 v32, v32, 0, s54
    v_lshl_add_u32 v166, v31, 15, v32
    s_lshl_b32 s50, s41, 22
    s_lshl_b32 s51, s44, 8
    s_add_u32 s51, s50, s51
    s_mov_b32 s63, s51
    s_add_u32 s64, s51, 256
    s_add_u32 s65, s51, 512
    s_add_u32 s66, s51, 768
    s_sub_u32 s52, s51, 256
    s_cmp_eq_u32 s42, 0
    s_cselect_b32 s62, s51, s52
    s_add_u32 s52, s51, 1024
    s_cmp_eq_u32 s42, 31
    s_cselect_b32 s67, s66, s52
    s_waitcnt lgkmcnt(0)
    s_mov_b32 s28, s4
    s_mov_b32 s29, s5
    s_mov_b32 s32, s26
    s_mov_b32 s33, s27
    v_and_b32 v20, 15, v1
    v_lshlrev_b32 v20, 2, v20
    global_load_dword v168, v20, s[8:9] offset:0
    global_load_dword v172, v20, s[10:11] offset:0
    global_load_dword v169, v20, s[8:9] offset:64
    global_load_dword v173, v20, s[10:11] offset:64
    global_load_dword v170, v20, s[8:9] offset:128
    global_load_dword v174, v20, s[10:11] offset:128
    global_load_dword v171, v20, s[8:9] offset:192
    global_load_dword v175, v20, s[10:11] offset:192
    s_barrier
    s_cmp_ge_u32 s2, 36
    s_cbranch_scc1 L_noeld
    s_lshl_b32 s50, s2, 13
    v_lshlrev_b32 v37, 2, v1
    v_add_u32 v37, s50, v37
    v_add_u32 v38, 4096, v37
    s_lshl_b32 s51, s2, 6
    v_lshrrev_b32 v39, 5, v1
    v_mul_u32_u24 v39, 2304, v39
    v_and_b32 v29, 31, v1
    v_lshl_add_u32 v39, v29, 1, v39
    v_add_u32 v39, s51, v39
    global_load_ushort v29, v39, s[6:7]
    global_load_dword v64, v37, s[14:15] offset:0
    global_load_dword v65, v37, s[14:15] offset:256
    global_load_dword v66, v37, s[14:15] offset:512
    global_load_dword v67, v37, s[14:15] offset:768
    global_load_dword v68, v37, s[14:15] offset:1024
    global_load_dword v69, v37, s[14:15] offset:1280
    global_load_dword v70, v37, s[14:15] offset:1536
    global_load_dword v71, v37, s[14:15] offset:1792
    global_load_dword v72, v37, s[14:15] offset:2048
    global_load_dword v73, v37, s[14:15] offset:2304
    global_load_dword v74, v37, s[14:15] offset:2560
    global_load_dword v75, v37, s[14:15] offset:2816
    global_load_dword v76, v37, s[14:15] offset:3072
    global_load_dword v77, v37, s[14:15] offset:3328
    global_load_dword v78, v37, s[14:15] offset:3584
    global_load_dword v79, v37, s[14:15] offset:3840
    global_load_dword v80, v38, s[14:15] offset:0
    global_load_dword v81, v38, s[14:15] offset:256
    global_load_dword v82, v38, s[14:15] offset:512
    global_load_dword v83, v38, s[14:15] offset:768
    global_load_dword v84, v38, s[14:15] offset:1024
    global_load_dword v85, v38, s[14:15] offset:1280
    global_load_dword v86, v38, s[14:15] offset:1536
    global_load_dword v87, v38, s[14:15] offset:1792
    global_load_dword v88, v38, s[14:15] offset:2048
    global_load_dword v89, v38, s[14:15] offset:2304
    global_load_dword v90, v38, s[14:15] offset:2560
    global_load_dword v91, v38, s[14:15] offset:2816
    global_load_dword v92, v38, s[14:15] offset:3072
    global_load_dword v93, v38, s[14:15] offset:3328
    global_load_dword v94, v38, s[14:15] offset:3584
    global_load_dword v95, v38, s[14:15] offset:3840
L_noeld:
    s_mov_b32 m0, 69824
    s_nop 0
    buffer_load_dwordx4 v164, s[28:31], s63 offen lds
    s_mov_b32 m0, 70848
    s_nop 0
    buffer_load_dwordx4 v165, s[28:31], s63 offen lds
    s_mov_b32 m0, 71872
    s_nop 0
    buffer_load_dwordx4 v166, s[28:31], s63 offen lds
    s_mov_b32 m0, 82112
    s_nop 0
    buffer_load_dwordx4 v164, s[28:31], s64 offen lds
    s_mov_b32 m0, 83136
    s_nop 0
    buffer_load_dwordx4 v165, s[28:31], s64 offen lds
    s_mov_b32 m0, 84160
    s_nop 0
    buffer_load_dwordx4 v166, s[28:31], s64 offen lds
    s_mov_b32 m0, 94400
    s_nop 0
    buffer_load_dwordx4 v164, s[28:31], s65 offen lds
    s_mov_b32 m0, 95424
    s_nop 0
    buffer_load_dwordx4 v165, s[28:31], s65 offen lds
    s_mov_b32 m0, 96448
    s_nop 0
    buffer_load_dwordx4 v166, s[28:31], s65 offen lds
    s_mov_b32 m0, 106688
    s_nop 0
    buffer_load_dwordx4 v164, s[28:31], s66 offen lds
    s_mov_b32 m0, 107712
    s_nop 0
    buffer_load_dwordx4 v165, s[28:31], s66 offen lds
    s_mov_b32 m0, 108736
    s_nop 0
    buffer_load_dwordx4 v166, s[28:31], s66 offen lds
    s_mov_b32 m0, 57536
    s_nop 0
    buffer_load_dwordx4 v164, s[28:31], s62 offen lds
    s_mov_b32 m0, 58560
    s_nop 0
    buffer_load_dwordx4 v165, s[28:31], s62 offen lds
    s_mov_b32 m0, 59584
    s_nop 0
    buffer_load_dwordx4 v166, s[28:31], s62 offen lds
    s_mov_b32 m0, 118976
    s_nop 0
    buffer_load_dwordx4 v164, s[28:31], s67 offen lds
    s_mov_b32 m0, 120000
    s_nop 0
    buffer_load_dwordx4 v165, s[28:31], s67 offen lds
    s_mov_b32 m0, 121024
    s_nop 0
    buffer_load_dwordx4 v166, s[28:31], s67 offen lds
    s_cmp_lt_u32 s2, 36
    s_cbranch_scc1 L_w3e
    s_branch L_w3rest
L_segA:
    s_lshl_b32 s50, s2, 2
    s_add_u32 s50, s50, s40
    s_cmp_eq_u32 s50, 257
    s_cbranch_scc1 L_ctl
L_ctl_back:
    v_lshlrev_b32 v30, 4, v0
    v_bfe_u32 v31, v0, 4, 3
    v_lshrrev_b32 v32, 1, v31
    v_mul_u32_u24 v32, 9248, v32
    v_and_b32 v31, 1, v31
    v_mul_u32_u24 v31, 8976, v31
    v_and_b32 v33, 15, v0
    v_lshlrev_b32 v33, 4, v33
    v_add3_u32 v31, v31, v32, v33
    v_mov_b32 v32, 0
    v_mov_b32 v33, 0
    v_mov_b32 v34, 0
    v_mov_b32 v35, 0
    ds_write_b128 v30, v[32:35] offset:0
    ds_write_b128 v30, v[32:35] offset:43200
    ds_write_b128 v30, v[32:35] offset:4096
    ds_write_b128 v30, v[32:35] offset:47296
    ds_write_b128 v30, v[32:35] offset:8192
    ds_write_b128 v30, v[32:35] offset:51392
    ds_write_b128 v31, v[32:35] offset:9248
    v_and_b32 v30, 15, v1
    v_lshrrev_b32 v31, 4, v1
    v_and_b32 v32, 31, v1
    v_mul_u32_u24 v32, 272, v32
    v_lshrrev_b32 v33, 5, v1
    v_lshl_add_u32 v3, v33, 4, v32
    s_mul_i32 s50, s40, 73728
    v_add_u32 v4, s50, v2
    v_mul_u32_u24 v34, 192, v30
    v_lshl_add_u32 v35, v31, 4, v34
    s_mul_i32 s50, s40, 12288
    s_add_u32 s50, s50, 69840
    v_add_u32 v6, s50, v35
    s_lshr_b32 s51, s40, 1
    s_and_b32 s52, s40, 1
    s_mul_i32 s50, s51, 61440
    s_lshl_b32 s53, s52, 5
    s_add_u32 s50, s50, s53
    s_add_u32 s50, s50, 57552
    v_lshl_add_u32 v35, v31, 3, v34
    v_add_u32 v7, s50, v35
    v_lshlrev_b32 v36, 2, v30
    v_mul_u32_u24 v37, 2176, v31
    v_add_u32 v37, v37, v36
    s_mul_i32 s50, s40, 9248
    s_add_u32 s50, s50, 9520
    v_add_u32 v9, s50, v37
    v_mul_u32_u24 v37, 1088, v31
    v_add_u32 v37, v37, v36
    s_mul_i32 s50, s51, 46240
    s_mul_i32 s53, s52, 4352
    s_add_u32 s50, s50, s53
    s_add_u32 s50, s50, 272
    s_cmp_eq_u32 s51, 0
    s_cselect_b32 s54, 0, 31
    s_cmp_lg_u32 s42, s54
    s_cselect_b32 s55, -1, 0
    v_add_u32 v37, s50, v37
    v_add_u32 v38, 55488, v36
    v_mov_b32 v39, s55
    v_cmp_ne_u32 vcc, 0, v39
    s_nop 1
    v_cndmask_b32 v10, v38, v37, vcc
    s_lshl_b32 s50, s40, 2
    v_add_u32 v37, s50, v31
    v_lshrrev_b32 v39, 1, v37
    v_and_b32 v31, 1, v37
    v_min_u32 v35, 5, v39
    v_mul_u32_u24 v35, 12288, v35
    v_add_u32 v35, v35, v34
    v_mul_u32_u24 v33, 66, v31
    v_add_u32 v35, v35, v33
    v_add_u32 v8, 57550, v35
    v_mul_u32_u24 v35, 9248, v39
    v_mul_u32_u24 v33, 8976, v31
    v_add3_u32 v35, v35, v33, v36
    v_cmp_gt_u32 vcc, 12, v37
    s_nop 0
    s_mov_b64 s[56:57], vcc
    s_cmp_eq_u32 s42, 0
    s_cselect_b32 s54, 0, 99
    v_cmp_ne_u32 vcc, s54, v39
    s_nop 0
    s_and_b64 s[56:57], s[56:57], vcc
    s_cmp_eq_u32 s42, 31
    s_cselect_b32 s54, 5, 99
    v_cmp_ne_u32 vcc, s54, v39
    s_nop 0
    s_and_b64 s[56:57], s[56:57], vcc
    s_cmp_eq_u32 s43, 0
    s_cselect_b32 s54, 0, 99
    v_cmp_ne_u32 vcc, s54, v31
    s_nop 0
    s_and_b64 s[56:57], s[56:57], vcc
    s_cmp_eq_u32 s43, 3
    s_cselect_b32 s54, 1, 99
    v_cmp_ne_u32 vcc, s54, v31
    s_nop 0
    s_and_b64 vcc, s[56:57], vcc
    v_cndmask_b32 v11, v38, v35, vcc
    s_mov_b32 s51, 0x3f803f80
    v_mov_b32 v20, 0
    v_mov_b32 v21, 0
    v_mov_b32 v22, 0
    v_mov_b32 v23, 0
    s_waitcnt vmcnt(15)
    v_dot2_f32_bf16 v20, v64, s51, v20
    v_dot2_f32_bf16 v22, v64, v64, v22
    v_dot2_f32_bf16 v21, v65, s51, v21
    v_dot2_f32_bf16 v23, v65, v65, v23
    v_dot2_f32_bf16 v20, v66, s51, v20
    v_dot2_f32_bf16 v22, v66, v66, v22
    v_dot2_f32_bf16 v21, v67, s51, v21
    v_dot2_f32_bf16 v23, v67, v67, v23
    s_waitcnt vmcnt(14)
    v_dot2_f32_bf16 v20, v68, s51, v20
    v_dot2_f32_bf16 v22, v68, v68, v22
    v_dot2_f32_bf16 v21, v69, s51, v21
    v_dot2_f32_bf16 v23, v69, v69, v23
    v_dot2_f32_bf16 v20, v70, s51, v20
    v_dot2_f32_bf16 v22, v70, v70, v22
    v_dot2_f32_bf16 v21, v71, s51, v21
    v_dot2_f32_bf16 v23, v71, v71, v23
    s_waitcnt vmcnt(13)
    v_dot2_f32_bf16 v20, v72, s51, v20
    v_dot2_f32_bf16 v22, v72, v72, v22
    v_dot2_f32_bf16 v21, v73, s51, v21
    v_dot2_f32_bf16 v23, v73, v73, v23
    v_dot2_f32_bf16 v20, v74, s51, v20
    v_dot2_f32_bf16 v22, v74, v74, v22
    v_dot2_f32_bf16 v21, v75, s51, v21
    v_dot2_f32_bf16 v23, v75, v75, v23
    s_waitcnt vmcnt(12)
    v_dot2_f32_bf16 v20, v76, s51, v20
    v_dot2_f32_bf16 v22, v76, v76, v22
    v_dot2_f32_bf16 v21, v77, s51, v21
    v_dot2_f32_bf16 v23, v77, v77, v23
    v_dot2_f32_bf16 v20, v78, s51, v20
    v_dot2_f32_bf16 v22, v78, v78, v22
    v_dot2_f32_bf16 v21, v79, s51, v21
    v_dot2_f32_bf16 v23, v79, v79, v23
    s_waitcnt vmcnt(11)
    v_dot2_f32_bf16 v20, v80, s51, v20
    v_dot2_f32_bf16 v22, v80, v80, v22
    v_dot2_f32_bf16 v21, v81, s51, v21
    v_dot2_f32_bf16 v23, v81, v81, v23
    v_dot2_f32_bf16 v20, v82, s51, v20
    v_dot2_f32_bf16 v22, v82, v82, v22
    v_dot2_f32_bf16 v21, v83, s51, v21
    v_dot2_f32_bf16 v23, v83, v83, v23
    s_waitcnt vmcnt(10)
    v_dot2_f32_bf16 v20, v84, s51, v20
    v_dot2_f32_bf16 v22, v84, v84, v22
    v_dot2_f32_bf16 v21, v85, s51, v21
    v_dot2_f32_bf16 v23, v85, v85, v23
    v_dot2_f32_bf16 v20, v86, s51, v20
    v_dot2_f32_bf16 v22, v86, v86, v22
    v_dot2_f32_bf16 v21, v87, s51, v21
    v_dot2_f32_bf16 v23, v87, v87, v23
    s_waitcnt vmcnt(9)
    v_dot2_f32_bf16 v20, v88, s51, v20
    v_dot2_f32_bf16 v22, v88, v88, v22
    v_dot2_f32_bf16 v21, v89, s51, v21
    v_dot2_f32_bf16 v23, v89, v89, v23
    v_dot2_f32_bf16 v20, v90, s51, v20
    v_dot2_f32_bf16 v22, v90, v90, v22
    v_dot2_f32_bf16 v21, v91, s51, v21
    v_dot2_f32_bf16 v23, v91, v91, v23
    s_waitcnt vmcnt(8)
    v_dot2_f32_bf16 v20, v92, s51, v20
    v_dot2_f32_bf16 v22, v92, v92, v22
    v_dot2_f32_bf16 v21, v93, s51, v21
    v_dot2_f32_bf16 v23, v93, v93, v23
    v_dot2_f32_bf16 v20, v94, s51, v20
    v_dot2_f32_bf16 v22, v94, v94, v22
    v_dot2_f32_bf16 v21, v95, s51, v21
    v_dot2_f32_bf16 v23, v95, v95, v23
    s_waitcnt vmcnt(7)
    v_dot2_f32_bf16 v20, v96, s51, v20
    v_dot2_f32_bf16 v22, v96, v96, v22
    v_dot2_f32_bf16 v21, v97, s51, v21
    v_dot2_f32_bf16 v23, v97, v97, v23
    v_dot2_f32_bf16 v20, v98, s51, v20
    v_dot2_f32_bf16 v22, v98, v98, v22
    v_dot2_f32_bf16 v21, v99, s51, v21
    v_dot2_f32_bf16 v23, v99, v99, v23
    s_waitcnt vmcnt(6)
    v_dot2_f32_bf16 v20, v100, s51, v20
    v_dot2_f32_bf16 v22, v100, v100, v22
    v_dot2_f32_bf16 v21, v101, s51, v21
    v_dot2_f32_bf16 v23, v101, v101, v23
    v_dot2_f32_bf16 v20, v102, s51, v20
    v_dot2_f32_bf16 v22, v102, v102, v22
    v_dot2_f32_bf16 v21, v103, s51, v21
    v_dot2_f32_bf16 v23, v103, v103, v23
    s_waitcnt vmcnt(5)
    v_dot2_f32_bf16 v20, v104, s51, v20
    v_dot2_f32_bf16 v22, v104, v104, v22
    v_dot2_f32_bf16 v21, v105, s51, v21
    v_dot2_f32_bf16 v23, v105, v105, v23
    v_dot2_f32_bf16 v20, v106, s51, v20
    v_dot2_f32_bf16 v22, v106, v106, v22
    v_dot2_f32_bf16 v21, v107, s51, v21
    v_dot2_f32_bf16 v23, v107, v107, v23
    s_waitcnt vmcnt(4)
    v_dot2_f32_bf16 v20, v108, s51, v20
    v_dot2_f32_bf16 v22, v108, v108, v22
    v_dot2_f32_bf16 v21, v109, s51, v21
    v_dot2_f32_bf16 v23, v109, v109, v23
    v_dot2_f32_bf16 v20, v110, s51, v20
    v_dot2_f32_bf16 v22, v110, v110, v22
    v_dot2_f32_bf16 v21, v111, s51, v21
    v_dot2_f32_bf16 v23, v111, v111, v23
    s_waitcnt vmcnt(3)
    v_dot2_f32_bf16 v20, v112, s51, v20
    v_dot2_f32_bf16 v22, v112, v112, v22
    v_dot2_f32_bf16 v21, v113, s51, v21
    v_dot2_f32_bf16 v23, v113, v113, v23
    v_dot2_f32_bf16 v20, v114, s51, v20
    v_dot2_f32_bf16 v22, v114, v114, v22
    v_dot2_f32_bf16 v21, v115, s51, v21
    v_dot2_f32_bf16 v23, v115, v115, v23
    s_waitcnt vmcnt(2)
    v_dot2_f32_bf16 v20, v116, s51, v20
    v_dot2_f32_bf16 v22, v116, v116, v22
    v_dot2_f32_bf16 v21, v117, s51, v21
    v_dot2_f32_bf16 v23, v117, v117, v23
    v_dot2_f32_bf16 v20, v118, s51, v20
    v_dot2_f32_bf16 v22, v118, v118, v22
    v_dot2_f32_bf16 v21, v119, s51, v21
    v_dot2_f32_bf16 v23, v119, v119, v23
    s_waitcnt vmcnt(1)
    v_dot2_f32_bf16 v20, v120, s51, v20
    v_dot2_f32_bf16 v22, v120, v120, v22
    v_dot2_f32_bf16 v21, v121, s51, v21
    v_dot2_f32_bf16 v23, v121, v121, v23
    v_dot2_f32_bf16 v20, v122, s51, v20
    v_dot2_f32_bf16 v22, v122, v122, v22
    v_dot2_f32_bf16 v21, v123, s51, v21
    v_dot2_f32_bf16 v23, v123, v123, v23
    s_waitcnt vmcnt(0)
    v_dot2_f32_bf16 v20, v124, s51, v20
    v_dot2_f32_bf16 v22, v124, v124, v22
    v_dot2_f32_bf16 v21, v125, s51, v21
    v_dot2_f32_bf16 v23, v125, v125, v23
    v_dot2_f32_bf16 v20, v126, s51, v20
    v_dot2_f32_bf16 v22, v126, v126, v22
    v_dot2_f32_bf16 v21, v127, s51, v21
    v_dot2_f32_bf16 v23, v127, v127, v23
    s_nop 1
    v_add_f32 v20, v20, v21
    v_add_f32 v21, v22, v23
    s_nop 0
    v_add_f32_dpp v20, v20, v20 row_shr:1 row_mask:0xf bank_mask:0xf
    v_add_f32_dpp v21, v21, v21 row_shr:1 row_mask:0xf bank_mask:0xf
    s_nop 0
    v_add_f32_dpp v20, v20, v20 row_shr:2 row_mask:0xf bank_mask:0xf
    v_add_f32_dpp v21, v21, v21 row_shr:2 row_mask:0xf bank_mask:0xf
    s_nop 0
    v_add_f32_dpp v20, v20, v20 row_shr:4 row_mask:0xf bank_mask:0xf
    v_add_f32_dpp v21, v21, v21 row_shr:4 row_mask:0xf bank_mask:0xf
    s_nop 0
    v_add_f32_dpp v20, v20, v20 row_shr:8 row_mask:0xf bank_mask:0xf
    v_add_f32_dpp v21, v21, v21 row_shr:8 row_mask:0xf bank_mask:0xf
    s_nop 0
    v_add_f32_dpp v20, v20, v20 row_bcast:15 row_mask:0xa bank_mask:0xf
    v_add_f32_dpp v21, v21, v21 row_bcast:15 row_mask:0xa bank_mask:0xf
    s_nop 0
    v_add_f32_dpp v20, v20, v20 row_bcast:31 row_mask:0xc bank_mask:0xf
    v_add_f32_dpp v21, v21, v21 row_bcast:31 row_mask:0xc bank_mask:0xf
    s_cmp_eq_u32 s40, 0
    s_cbranch_scc1 L_w0arr
    s_waitcnt vmcnt(0)
    v_mov_b32 v31, 131264
    s_mov_b32 exec_lo, 0
    s_mov_b32 exec_hi, 0x80000000
    ds_write_b64 v31, v[20:21]
    s_mov_b64 exec, -1
    s_branch L_w1rest
L_w0arr:
    v_readlane_b32 s52, v20, 63
    v_readlane_b32 s53, v21, 63
    v_mov_b32 v31, 131264
    s_lshr_b32 s50, s2, 7
    s_lshl_b32 s50, s50, 10
    s_lshl_b32 s51, s41, 11
    s_add_u32 s50, s50, s51
    s_and_b32 s51, s2, 3
    s_lshl_b32 s51, s51, 2
    s_lshr_b32 s54, s2, 5
    s_and_b32 s54, s54, 3
    s_add_u32 s51, s51, s54
    s_lshl_b32 s54, s43, 4
    s_add_u32 s51, s51, s54
    s_lshl_b32 s51, s51, 4
    s_add_u32 s50, s50, s51
    s_add_u32 s55, s50, 614400
    v_lshlrev_b32 v27, 12, v1
    s_cmp_lt_u32 s2, 128
    s_cselect_b32 s61, -1, 0
    s_mov_b32 s70, 0
L_flag:
    ds_read_b128 v[32:35], v31
    s_add_u32 s70, s70, 1
    s_waitcnt lgkmcnt(0)
    v_and_b32 v34, s61, v34
    v_max3_u32 v36, v32, v33, v34
    v_max_u32 v36, v36, v35
    v_cmp_eq_u32 vcc, -1, v36
    s_nop 0
    s_cbranch_vccz L_flag_ok
    s_cmp_lt_u32 s70, 160000
    s_cbranch_scc1 L_flag
L_flag_ok:
    v_add_f32 v28, s52, v32
    v_mov_b32 v29, v35
    v_add_f32 v30, s53, v33
    v_mov_b32 v31, v35
    v_mov_b32 v36, 131264
    s_mov_b64 exec, 3
    buffer_store_dwordx4 v[28:31], v27, s[32:35], s55 offen sc1
    s_mov_b64 exec, -1
    ds_write_b32 v36, v27 offset:16
    v_readfirstlane_b32 s60, v35
    v_and_b32 v20, 15, v1
    v_lshlrev_b32 v20, 2, v20
    global_load_dword v168, v20, s[8:9] offset:0
    global_load_dword v172, v20, s[10:11] offset:0
    global_load_dword v169, v20, s[8:9] offset:64
    global_load_dword v173, v20, s[10:11] offset:64
    global_load_dword v170, v20, s[8:9] offset:128
    global_load_dword v174, v20, s[10:11] offset:128
    global_load_dword v171, v20, s[8:9] offset:192
    global_load_dword v175, v20, s[10:11] offset:192
    s_lshl_b32 s50, s41, 5
    s_add_u32 s50, s50, s42
    s_lshl_b32 s50, s50, 2
    s_add_u32 s46, s50, s43
    s_mov_b32 s47, 0xffff0000
    s_mov_b32 s48, 0xbf317218
    s_mov_b32 s49, 0xbf317218
    s_mov_b32 s36, s22
    s_mov_b32 s37, s23
    s_mov_b32 s38, 0x800000
    s_mov_b32 s39, 0x20000
    s_lshl_b32 s50, s46, 15
    s_lshl_b32 s51, s40, 11
    s_add_u32 s50, s50, s51
    s_add_u32 s71, s50, 1048576
    s_mov_b32 s72, s71
    s_add_u32 s73, s71, 8192
    s_add_u32 s74, s71, 16384
    s_add_u32 s75, s71, 24576
    s_sub_u32 s52, s71, 106496
    s_cmp_eq_u32 s42, 0
    s_cselect_b32 s76, s71, s52
    s_add_u32 s53, s71, 131072
    s_cmp_eq_u32 s42, 31
    s_cselect_b32 s77, s71, s53
    s_add_u32 s78, s51, 1048576
    s_lshl_b32 s50, s41, 22
    s_lshl_b32 s51, s40, 20
    s_add_u32 s50, s50, s51
    s_lshl_b32 s51, s44, 8
    s_add_u32 s50, s50, s51
    s_add_u32 s79, s50, s45
    s_lshl_b32 s50, s41, 2
    s_add_u32 s50, s50, s40
    s_mul_i32 s51, s50, 4608
    s_add_u32 s85, s51, 622592
    s_add_u32 s86, s85, 4096
    s_lshl_b32 s51, s50, 11
    s_add_u32 s51, s51, 589824
    s_lshl_b32 s52, s42, 2
    s_add_u32 s52, s52, s43
    s_lshl_b32 s52, s52, 3
    s_add_u32 s80, s51, s52
    s_and_b32 s52, s2, 1
    s_lshl_b32 s52, s52, 10
    s_add_u32 s81, s51, s52
    s_mov_b64 s[82:83], 0x3f
    s_lshl_b32 s52, s42, 1
    s_sub_u32 s52, s52, 2
    s_lshl_b64 s[82:83], s[82:83], s52
    s_cmp_eq_u32 s42, 0
    s_cselect_b64 s[82:83], 15, s[82:83]
    v_and_b32 v56, 31, v1
    v_lshrrev_b32 v57, 5, v1
    s_lshl_b32 s50, s40, 4
    v_lshl_add_u32 v58, v57, 3, s50
    v_mul_u32_u24 v59, 272, v56
    v_add_u32 v59, v59, v58
    v_add_u32 v12, 272, v59
    v_add_u32 v60, 55488, v58
    s_cmp_lg_u32 s42, 0
    s_cselect_b32 s54, -1, 0
    v_mov_b32 v61, s54
    v_cmp_ne_u32 vcc, 0, v61
    s_nop 1
    v_cndmask_b32 v13, v60, v12, vcc
    v_add_u32 v62, 46240, v12
    s_cmp_lg_u32 s42, 31
    s_cselect_b32 s54, -1, 0
    v_mov_b32 v61, s54
    v_cmp_ne_u32 vcc, 0, v61
    s_nop 1
    v_cndmask_b32 v14, v60, v62, vcc
    v_lshrrev_b32 v61, 1, v56
    v_and_b32 v62, 1, v56
    v_mul_u32_u24 v63, 9248, v61
    v_mul_u32_u24 v20, 8976, v62
    v_add3_u32 v63, v63, v20, v58
    v_cmp_gt_u32 vcc, 12, v56
    s_nop 0
    s_mov_b64 s[56:57], vcc
    s_cmp_eq_u32 s42, 0
    s_cselect_b32 s54, 0, 99
    v_cmp_ne_u32 vcc, s54, v61
    s_nop 0
    s_and_b64 s[56:57], s[56:57], vcc
    s_cmp_eq_u32 s42, 31
    s_cselect_b32 s54, 5, 99
    v_cmp_ne_u32 vcc, s54, v61
    s_nop 0
    s_and_b64 s[56:57], s[56:57], vcc
    s_cmp_eq_u32 s43, 0
    s_cselect_b32 s54, 0, 99
    v_cmp_ne_u32 vcc, s54, v62
    s_nop 0
    s_and_b64 s[56:57], s[56:57], vcc
    s_cmp_eq_u32 s43, 3
    s_cselect_b32 s54, 1, 99
    v_cmp_ne_u32 vcc, s54, v62
    s_nop 0
    s_and_b64 s[56:57], s[56:57], vcc
    s_mov_b64 vcc, s[56:57]
    v_cndmask_b32 v15, v60, v63, vcc
    v_cmp_eq_u32 vcc, 0, v61
    s_nop 1
    v_cndmask_b32 v63, 0, -4, vcc
    v_add_u32 v20, -1, v61
    v_cndmask_b32 v20, v20, 3, vcc
    v_cmp_eq_u32 vcc, 5, v61
    s_nop 1
    v_cndmask_b32 v63, v63, 4, vcc
    v_cndmask_b32 v20, v20, 0, vcc
    v_lshl_add_u32 v63, v62, 1, v63
    v_add_u32 v63, -1, v63
    v_add_u32 v63, s46, v63
    v_lshlrev_b32 v63, 15, v63
    v_lshl_add_u32 v63, v20, 13, v63
    v_lshlrev_b32 v20, 5, v57
    v_xor_b32 v21, 1, v62
    v_mul_u32_u24 v21, 31, v21
    v_add_u32 v20, v20, v21
    v_lshl_add_u32 v63, v20, 4, v63
    s_lshl_b32 s54, s46, 15
    v_mov_b32 v20, s54
    s_mov_b64 vcc, s[56:57]
    v_cndmask_b32 v16, v20, v63, vcc
    v_lshlrev_b32 v59, 15, v56
    v_lshl_add_u32 v17, v57, 4, v59
    v_and_b32 v59, 15, v1
    v_lshlrev_b32 v59, 15, v59
    v_lshl_add_u32 v17, v57, 4, v59
    v_bfe_u32 v59, v1, 4, 1
    v_lshl_add_u32 v17, v59, 5, v17
    s_mul_i32 s50, s40, 3072
    s_add_u32 s50, s50, 57552
    v_mul_u32_u24 v59, 96, v56
    v_lshl_add_u32 v59, v57, 3, v59
    v_add_u32 v18, s50, v59
    v_cmp_eq_u32 vcc, 0, v56
    v_cmp_eq_u32 s[56:57], 31, v56
    s_nop 0
    s_or_b64 vcc, vcc, s[56:57]
    v_mov_b32 v59, 1073741824
    v_cndmask_b32 v5, v59, v2, vcc
    s_sub_i32 s53, s45, 16
    s_movk_i32 s54, 240
    s_lshl_b32 s55, s40, 1
    s_lshr_b32 s55, 0x18, s55
    s_and_b32 s55, s55, 3
    s_add_u32 s56, s55, 0
    s_cmp_ge_u32 s56, 3
    s_cselect_b32 s57, 3, 0
    s_sub_u32 s56, s56, s57
    s_lshl_b32 s56, s56, 6
    v_add_u32 v30, s56, v1
    v_mul_u32_u24 v31, 171, v30
    v_lshrrev_b32 v31, 10, v31
    v_mul_u32_u24 v32, 6, v31
    v_sub_u32 v32, v30, v32
    v_lshl_add_u32 v32, v32, 4, s53
    v_med3_i32 v32, v32, 0, s54
    v_lshl_add_u32 v164, v31, 15, v32
    s_add_u32 s56, s55, 1
    s_cmp_ge_u32 s56, 3
    s_cselect_b32 s57, 3, 0
    s_sub_u32 s56, s56, s57
    s_lshl_b32 s56, s56, 6
    v_add_u32 v30, s56, v1
    v_mul_u32_u24 v31, 171, v30
    v_lshrrev_b32 v31, 10, v31
    v_mul_u32_u24 v32, 6, v31
    v_sub_u32 v32, v30, v32
    v_lshl_add_u32 v32, v32, 4, s53
    v_med3_i32 v32, v32, 0, s54
    v_lshl_add_u32 v165, v31, 15, v32
    s_add_u32 s56, s55, 2
    s_cmp_ge_u32 s56, 3
    s_cselect_b32 s57, 3, 0
    s_sub_u32 s56, s56, s57
    s_lshl_b32 s56, s56, 6
    v_add_u32 v30, s56, v1
    v_mul_u32_u24 v31, 171, v30
    v_lshrrev_b32 v31, 10, v31
    v_mul_u32_u24 v32, 6, v31
    v_sub_u32 v32, v30, v32
    v_lshl_add_u32 v32, v32, 4, s53
    v_med3_i32 v32, v32, 0, s54
    v_lshl_add_u32 v166, v31, 15, v32
    s_lshl_b32 s52, s41, 22
    s_lshl_b32 s53, s44, 8
    s_add_u32 s52, s52, s53
    s_add_u32 s52, s52, 3145472
    s_mul_i32 s50, s40, 5
    s_cmp_eq_u32 s42, 0
    s_cselect_b32 s54, 1, 0
    s_cmp_eq_u32 s42, 31
    s_cselect_b32 s55, 4, 5
    v_add_u32 v30, s50, v1
    v_mov_b32 v33, s55
    v_cmp_le_u32 vcc, 18, v30
    s_nop 1
    v_cndmask_b32 v31, 0, 3, vcc
    v_sub_u32 v30, v30, v31
    v_mul_u32_u24 v31, 43, v30
    v_lshrrev_b32 v31, 7, v31
    v_mul_u32_u24 v32, 3, v31
    v_sub_u32 v32, v30, v32
    v_lshlrev_b32 v32, 10, v32
    v_mul_u32_u24 v30, 12288, v31
    v_med3_u32 v31, v31, s54, v33
    v_add_u32 v32, 63680, v32
    v_lshl_add_u32 v31, v31, 8, s52
    v_add_u32 v32, v32, v30
    v_readlane_b32 s62, v31, 0
    v_readlane_b32 s67, v32, 0
    v_readlane_b32 s63, v31, 1
    v_readlane_b32 s68, v32, 1
    v_readlane_b32 s64, v31, 2
    v_readlane_b32 s71, v32, 2
    v_readlane_b32 s65, v31, 3
    v_readlane_b32 s84, v32, 3
    v_readlane_b32 s66, v31, 4
    v_readlane_b32 s96, v32, 4
    v_mov_b32 v56, 0
    v_mov_b32 v57, 0
    v_mov_b32 v58, 0
    v_mov_b32 v59, 0
    s_waitcnt lgkmcnt(0)
    s_barrier
    v_mov_b32 v22, 0
    v_mov_b32 v23, 0
    ds_read_b128 v[44:47], v6 offset:0
    ds_read_b128 v[48:51], v6 offset:96
    ds_read_b64 v[52:53], v7 offset:0
    ds_read_b64 v[54:55], v7 offset:96
    ds_read_u16_d16_hi v22, v8 offset:0
    ds_read_u16_d16_hi v23, v8 offset:96
    s_waitcnt lgkmcnt(5)
    v_lshlrev_b32 v136, 16, v44
    s_waitcnt lgkmcnt(4)
    v_lshlrev_b32 v137, 16, v48
    v_and_b32 v138, s47, v44
    v_and_b32 v139, s47, v48
    v_lshlrev_b32 v140, 16, v45
    v_lshlrev_b32 v141, 16, v49
    v_and_b32 v142, s47, v45
    v_and_b32 v143, s47, v49
    v_lshlrev_b32 v144, 16, v46
    v_lshlrev_b32 v145, 16, v50
    v_and_b32 v146, s47, v46
    v_and_b32 v147, s47, v50
    v_lshlrev_b32 v148, 16, v47
    v_lshlrev_b32 v149, 16, v51
    v_and_b32 v150, s47, v47
    v_and_b32 v151, s47, v51
    s_waitcnt lgkmcnt(3)
    v_lshlrev_b32 v152, 16, v52
    s_waitcnt lgkmcnt(2)
    v_lshlrev_b32 v153, 16, v54
    v_and_b32 v154, s47, v52
    v_and_b32 v155, s47, v54
    v_lshlrev_b32 v156, 16, v53
    v_lshlrev_b32 v157, 16, v55
    v_and_b32 v158, s47, v53
    v_and_b32 v159, s47, v55
    s_waitcnt lgkmcnt(1)
    v_mov_b32 v160, v22
    s_waitcnt lgkmcnt(0)
    v_mov_b32 v161, v23
    s_waitcnt vmcnt(7)
    v_lshlrev_b32 v24, 16, v168
    v_and_b32 v25, s47, v168
    s_waitcnt vmcnt(6)
    v_lshlrev_b32 v26, 16, v172
    v_and_b32 v27, s47, v172
    s_waitcnt vmcnt(5)
    v_lshlrev_b32 v28, 16, v169
    v_and_b32 v29, s47, v169
    s_waitcnt vmcnt(4)
    v_lshlrev_b32 v30, 16, v173
    v_and_b32 v31, s47, v173
    s_waitcnt vmcnt(3)
    v_lshlrev_b32 v32, 16, v170
    v_and_b32 v33, s47, v170
    s_waitcnt vmcnt(2)
    v_lshlrev_b32 v34, 16, v174
    v_and_b32 v35, s47, v174
    s_waitcnt vmcnt(1)
    v_lshlrev_b32 v36, 16, v171
    v_and_b32 v37, s47, v171
    s_waitcnt vmcnt(0)
    v_lshlrev_b32 v38, 16, v175
    v_and_b32 v39, s47, v175
    s_mov_b32 s50, 0xbfb8aa3b
    v_mul_f32 v24, s50, v24
    v_mul_f32 v25, s50, v25
    v_mul_f32 v26, s50, v26
    v_mul_f32 v27, s50, v27
    v_mul_f32 v28, s50, v28
    v_mul_f32 v29, s50, v29
    v_mul_f32 v30, s50, v30
    v_mul_f32 v31, s50, v31
    v_mul_f32 v32, s50, v32
    v_mul_f32 v33, s50, v33
    v_mul_f32 v34, s50, v34
    v_mul_f32 v35, s50, v35
    v_mul_f32 v36, s50, v36
    v_mul_f32 v37, s50, v37
    v_mul_f32 v38, s50, v38
    v_mul_f32 v39, s50, v39
    s_and_b32 s50, s2, 1
    s_lshl_b32 s50, s50, 12
    s_add_u32 s50, s50, 614400
    s_lshl_b32 s51, s41, 11
    s_add_u32 s52, s50, s51
    s_xor_b32 s51, s51, 2048
    s_add_u32 s53, s50, s51
    s_mov_b32 s70, 0
L_poll1:
    buffer_load_dwordx4 v[40:43], v2, s[32:35], s52 offen sc1
    buffer_load_dwordx4 v[44:47], v2, s[32:35], s52 offen offset:1024 sc1
    buffer_load_dwordx4 v[48:51], v2, s[32:35], s53 offen sc1
    s_add_u32 s70, s70, 1
    s_waitcnt vmcnt(0)
    v_xor_b32 v52, s60, v41
    v_xor_b32 v53, s60, v43
    v_xor_b32 v54, s60, v45
    v_xor_b32 v55, s60, v47
    v_or3_b32 v52, v52, v53, v54
    v_xor_b32 v53, s60, v49
    v_xor_b32 v54, s60, v51
    v_or3_b32 v52, v52, v55, v53
    v_or_b32 v52, v52, v54
    v_cmp_ne_u32 vcc, 0, v52
    s_nop 0
    s_cbranch_vccz L_poll1_done
    s_cmp_ge_u32 s70, 20000
    s_cbranch_scc1 L_poll1_done
    s_sleep 4
    s_branch L_poll1
L_poll1_done:
    v_add_f32 v40, v40, v44
    v_add_f32 v42, v42, v46
    s_nop 0
    v_add_f32_dpp v40, v40, v40 row_shr:1 row_mask:0xf bank_mask:0xf
    v_add_f32_dpp v42, v42, v42 row_shr:1 row_mask:0xf bank_mask:0xf
    s_nop 0
    v_add_f32_dpp v40, v40, v40 row_shr:2 row_mask:0xf bank_mask:0xf
    v_add_f32_dpp v42, v42, v42 row_shr:2 row_mask:0xf bank_mask:0xf
    s_nop 0
    v_add_f32_dpp v40, v40, v40 row_shr:4 row_mask:0xf bank_mask:0xf
    v_add_f32_dpp v42, v42, v42 row_shr:4 row_mask:0xf bank_mask:0xf
    s_nop 0
    v_add_f32_dpp v40, v40, v40 row_shr:8 row_mask:0xf bank_mask:0xf
    v_add_f32_dpp v42, v42, v42 row_shr:8 row_mask:0xf bank_mask:0xf
    v_lshrrev_b32 v44, 4, v1
    v_lshlrev_b32 v44, 3, v44
    v_add_u32 v44, 131296, v44
    v_mul_f32 v40, 0x36000000, v40
    v_mul_f32 v42, 0x36000000, v42
    v_fma_f32 v42, -v40, v40, v42
    v_max_f32 v42, 0, v42
    v_add_f32 v42, 0x3727c5ac, v42
    v_rsq_f32 v41, v42
    s_mov_b32 exec_lo, 0x80008000
    s_mov_b32 exec_hi, 0x80008000
    ds_write_b64 v44, v[40:41]
    s_mov_b64 exec, -1
    s_waitcnt lgkmcnt(0)
    s_barrier
    s_branch L_common
L_ctl:
    v_mov_b32 v32, -1
    v_mov_b32 v33, -1
    v_mov_b32 v34, -1
    v_mov_b32 v35, -1
    s_mov_b32 s50, 589824
    buffer_store_dwordx4 v[32:35], v2, s[32:35], s50 offen offset:0 sc1
    buffer_store_dwordx4 v[32:35], v2, s[32:35], s50 offen offset:1024 sc1
    buffer_store_dwordx4 v[32:35], v2, s[32:35], s50 offen offset:2048 sc1
    buffer_store_dwordx4 v[32:35], v2, s[32:35], s50 offen offset:3072 sc1
    s_mov_b32 s50, 593920
    buffer_store_dwordx4 v[32:35], v2, s[32:35], s50 offen offset:0 sc1
    buffer_store_dwordx4 v[32:35], v2, s[32:35], s50 offen offset:1024 sc1
    buffer_store_dwordx4 v[32:35], v2, s[32:35], s50 offen offset:2048 sc1
    buffer_store_dwordx4 v[32:35], v2, s[32:35], s50 offen offset:3072 sc1
    s_mov_b32 s50, 598016
    buffer_store_dwordx4 v[32:35], v2, s[32:35], s50 offen offset:0 sc1
    buffer_store_dwordx4 v[32:35], v2, s[32:35], s50 offen offset:1024 sc1
    buffer_store_dwordx4 v[32:35], v2, s[32:35], s50 offen offset:2048 sc1
    buffer_store_dwordx4 v[32:35], v2, s[32:35], s50 offen offset:3072 sc1
    s_mov_b32 s50, 602112
    buffer_store_dwordx4 v[32:35], v2, s[32:35], s50 offen offset:0 sc1
    buffer_store_dwordx4 v[32:35], v2, s[32:35], s50 offen offset:1024 sc1
    buffer_store_dwordx4 v[32:35], v2, s[32:35], s50 offen offset:2048 sc1
    buffer_store_dwordx4 v[32:35], v2, s[32:35], s50 offen offset:3072 sc1
    s_nop 1
    s_branch L_ctl_back
L_w1rest:
    v_and_b32 v20, 15, v1
    v_lshlrev_b32 v20, 2, v20
    global_load_dword v168, v20, s[8:9] offset:0
    global_load_dword v172, v20, s[10:11] offset:0
    global_load_dword v169, v20, s[8:9] offset:64
    global_load_dword v173, v20, s[10:11] offset:64
    global_load_dword v170, v20, s[8:9] offset:128
    global_load_dword v174, v20, s[10:11] offset:128
    global_load_dword v171, v20, s[8:9] offset:192
    global_load_dword v175, v20, s[10:11] offset:192
    s_lshl_b32 s50, s41, 5
    s_add_u32 s50, s50, s42
    s_lshl_b32 s50, s50, 2
    s_add_u32 s46, s50, s43
    s_mov_b32 s47, 0xffff0000
    s_mov_b32 s48, 0xbf317218
    s_mov_b32 s49, 0xbf317218
    s_mov_b32 s36, s22
    s_mov_b32 s37, s23
    s_mov_b32 s38, 0x800000
    s_mov_b32 s39, 0x20000
    s_lshl_b32 s50, s46, 15
    s_lshl_b32 s51, s40, 11
    s_add_u32 s50, s50, s51
    s_add_u32 s71, s50, 1048576
    s_mov_b32 s72, s71
    s_add_u32 s73, s71, 8192
    s_add_u32 s74, s71, 16384
    s_add_u32 s75, s71, 24576
    s_sub_u32 s52, s71, 106496
    s_cmp_eq_u32 s42, 0
    s_cselect_b32 s76, s71, s52
    s_add_u32 s53, s71, 131072
    s_cmp_eq_u32 s42, 31
    s_cselect_b32 s77, s71, s53
    s_add_u32 s78, s51, 1048576
    s_lshl_b32 s50, s41, 22
    s_lshl_b32 s51, s40, 20
    s_add_u32 s50, s50, s51
    s_lshl_b32 s51, s44, 8
    s_add_u32 s50, s50, s51
    s_add_u32 s79, s50, s45
    s_lshl_b32 s50, s41, 2
    s_add_u32 s50, s50, s40
    s_mul_i32 s51, s50, 4608
    s_add_u32 s85, s51, 622592
    s_add_u32 s86, s85, 4096
    s_lshl_b32 s51, s50, 11
    s_add_u32 s51, s51, 589824
    s_lshl_b32 s52, s42, 2
    s_add_u32 s52, s52, s43
    s_lshl_b32 s52, s52, 3
    s_add_u32 s80, s51, s52
    s_and_b32 s52, s2, 1
    s_lshl_b32 s52, s52, 10
    s_add_u32 s81, s51, s52
    s_mov_b64 s[82:83], 0x3f
    s_lshl_b32 s52, s42, 1
    s_sub_u32 s52, s52, 2
    s_lshl_b64 s[82:83], s[82:83], s52
    s_cmp_eq_u32 s42, 0
    s_cselect_b64 s[82:83], 15, s[82:83]
    v_and_b32 v56, 31, v1
    v_lshrrev_b32 v57, 5, v1
    s_lshl_b32 s50, s40, 4
    v_lshl_add_u32 v58, v57, 3, s50
    v_mul_u32_u24 v59, 272, v56
    v_add_u32 v59, v59, v58
    v_add_u32 v12, 272, v59
    v_add_u32 v60, 55488, v58
    s_cmp_lg_u32 s42, 0
    s_cselect_b32 s54, -1, 0
    v_mov_b32 v61, s54
    v_cmp_ne_u32 vcc, 0, v61
    s_nop 1
    v_cndmask_b32 v13, v60, v12, vcc
    v_add_u32 v62, 46240, v12
    s_cmp_lg_u32 s42, 31
    s_cselect_b32 s54, -1, 0
    v_mov_b32 v61, s54
    v_cmp_ne_u32 vcc, 0, v61
    s_nop 1
    v_cndmask_b32 v14, v60, v62, vcc
    v_lshrrev_b32 v61, 1, v56
    v_and_b32 v62, 1, v56
    v_mul_u32_u24 v63, 9248, v61
    v_mul_u32_u24 v20, 8976, v62
    v_add3_u32 v63, v63, v20, v58
    v_cmp_gt_u32 vcc, 12, v56
    s_nop 0
    s_mov_b64 s[56:57], vcc
    s_cmp_eq_u32 s42, 0
    s_cselect_b32 s54, 0, 99
    v_cmp_ne_u32 vcc, s54, v61
    s_nop 0
    s_and_b64 s[56:57], s[56:57], vcc
    s_cmp_eq_u32 s42, 31
    s_cselect_b32 s54, 5, 99
    v_cmp_ne_u32 vcc, s54, v61
    s_nop 0
    s_and_b64 s[56:57], s[56:57], vcc
    s_cmp_eq_u32 s43, 0
    s_cselect_b32 s54, 0, 99
    v_cmp_ne_u32 vcc, s54, v62
    s_nop 0
    s_and_b64 s[56:57], s[56:57], vcc
    s_cmp_eq_u32 s43, 3
    s_cselect_b32 s54, 1, 99
    v_cmp_ne_u32 vcc, s54, v62
    s_nop 0
    s_and_b64 s[56:57], s[56:57], vcc
    s_mov_b64 vcc, s[56:57]
    v_cndmask_b32 v15, v60, v63, vcc
    v_cmp_eq_u32 vcc, 0, v61
    s_nop 1
    v_cndmask_b32 v63, 0, -4, vcc
    v_add_u32 v20, -1, v61
    v_cndmask_b32 v20, v20, 3, vcc
    v_cmp_eq_u32 vcc, 5, v61
    s_nop 1
    v_cndmask_b32 v63, v63, 4, vcc
    v_cndmask_b32 v20, v20, 0, vcc
    v_lshl_add_u32 v63, v62, 1, v63
    v_add_u32 v63, -1, v63
    v_add_u32 v63, s46, v63
    v_lshlrev_b32 v63, 15, v63
    v_lshl_add_u32 v63, v20, 13, v63
    v_lshlrev_b32 v20, 5, v57
    v_xor_b32 v21, 1, v62
    v_mul_u32_u24 v21, 31, v21
    v_add_u32 v20, v20, v21
    v_lshl_add_u32 v63, v20, 4, v63
    s_lshl_b32 s54, s46, 15
    v_mov_b32 v20, s54
    s_mov_b64 vcc, s[56:57]
    v_cndmask_b32 v16, v20, v63, vcc
    v_lshlrev_b32 v59, 15, v56
    v_lshl_add_u32 v17, v57, 4, v59
    v_and_b32 v59, 15, v1
    v_lshlrev_b32 v59, 15, v59
    v_lshl_add_u32 v17, v57, 4, v59
    v_bfe_u32 v59, v1, 4, 1
    v_lshl_add_u32 v17, v59, 5, v17
    s_mul_i32 s50, s40, 3072
    s_add_u32 s50, s50, 57552
    v_mul_u32_u24 v59, 96, v56
    v_lshl_add_u32 v59, v57, 3, v59
    v_add_u32 v18, s50, v59
    v_cmp_eq_u32 vcc, 0, v56
    v_cmp_eq_u32 s[56:57], 31, v56
    s_nop 0
    s_or_b64 vcc, vcc, s[56:57]
    v_mov_b32 v59, 1073741824
    v_cndmask_b32 v5, v59, v2, vcc
    s_sub_i32 s53, s45, 16
    s_movk_i32 s54, 240
    s_lshl_b32 s55, s40, 1
    s_lshr_b32 s55, 0x18, s55
    s_and_b32 s55, s55, 3
    s_add_u32 s56, s55, 0
    s_cmp_ge_u32 s56, 3
    s_cselect_b32 s57, 3, 0
    s_sub_u32 s56, s56, s57
    s_lshl_b32 s56, s56, 6
    v_add_u32 v30, s56, v1
    v_mul_u32_u24 v31, 171, v30
    v_lshrrev_b32 v31, 10, v31
    v_mul_u32_u24 v32, 6, v31
    v_sub_u32 v32, v30, v32
    v_lshl_add_u32 v32, v32, 4, s53
    v_med3_i32 v32, v32, 0, s54
    v_lshl_add_u32 v164, v31, 15, v32
    s_add_u32 s56, s55, 1
    s_cmp_ge_u32 s56, 3
    s_cselect_b32 s57, 3, 0
    s_sub_u32 s56, s56, s57
    s_lshl_b32 s56, s56, 6
    v_add_u32 v30, s56, v1
    v_mul_u32_u24 v31, 171, v30
    v_lshrrev_b32 v31, 10, v31
    v_mul_u32_u24 v32, 6, v31
    v_sub_u32 v32, v30, v32
    v_lshl_add_u32 v32, v32, 4, s53
    v_med3_i32 v32, v32, 0, s54
    v_lshl_add_u32 v165, v31, 15, v32
    s_add_u32 s56, s55, 2
    s_cmp_ge_u32 s56, 3
    s_cselect_b32 s57, 3, 0
    s_sub_u32 s56, s56, s57
    s_lshl_b32 s56, s56, 6
    v_add_u32 v30, s56, v1
    v_mul_u32_u24 v31, 171, v30
    v_lshrrev_b32 v31, 10, v31
    v_mul_u32_u24 v32, 6, v31
    v_sub_u32 v32, v30, v32
    v_lshl_add_u32 v32, v32, 4, s53
    v_med3_i32 v32, v32, 0, s54
    v_lshl_add_u32 v166, v31, 15, v32
    s_lshl_b32 s52, s41, 22
    s_lshl_b32 s53, s44, 8
    s_add_u32 s52, s52, s53
    s_add_u32 s52, s52, 3145472
    s_mul_i32 s50, s40, 5
    s_cmp_eq_u32 s42, 0
    s_cselect_b32 s54, 1, 0
    s_cmp_eq_u32 s42, 31
    s_cselect_b32 s55, 4, 5
    v_add_u32 v30, s50, v1
    v_mov_b32 v33, s55
    v_cmp_le_u32 vcc, 18, v30
    s_nop 1
    v_cndmask_b32 v31, 0, 3, vcc
    v_sub_u32 v30, v30, v31
    v_mul_u32_u24 v31, 43, v30
    v_lshrrev_b32 v31, 7, v31
    v_mul_u32_u24 v32, 3, v31
    v_sub_u32 v32, v30, v32
    v_lshlrev_b32 v32, 10, v32
    v_mul_u32_u24 v30, 12288, v31
    v_med3_u32 v31, v31, s54, v33
    v_add_u32 v32, 63680, v32
    v_lshl_add_u32 v31, v31, 8, s52
    v_add_u32 v32, v32, v30
    v_readlane_b32 s62, v31, 0
    v_readlane_b32 s67, v32, 0
    v_readlane_b32 s63, v31, 1
    v_readlane_b32 s68, v32, 1
    v_readlane_b32 s64, v31, 2
    v_readlane_b32 s71, v32, 2
    v_readlane_b32 s65, v31, 3
    v_readlane_b32 s84, v32, 3
    v_readlane_b32 s66, v31, 4
    v_readlane_b32 s96, v32, 4
    v_mov_b32 v56, 0
    v_mov_b32 v57, 0
    v_mov_b32 v58, 0
    v_mov_b32 v59, 0
    v_mov_b32 v31, 131264
    s_mov_b32 s70, 0
L_cgate:
    ds_read_b32 v30, v31 offset:16
    s_add_u32 s70, s70, 1
    s_waitcnt lgkmcnt(0)
    v_readfirstlane_b32 s50, v30
    s_nop 0
    s_cmp_lg_u32 s50, -1
    s_cbranch_scc1 L_cgate_ok
    s_cmp_lt_u32 s70, 160000
    s_cbranch_scc1 L_cgate
L_cgate_ok:
    v_mov_b32 v32, -1
    v_mov_b32 v33, -1
    v_mov_b32 v34, -1
    v_mov_b32 v35, -1
    s_add_u32 s50, s46, 0
    s_lshl_b32 s50, s50, 15
    s_add_u32 s50, s50, 1048576
    v_lshrrev_b32 v36, 5, v1
    v_add_u32 v36, 1, v36
    v_lshlrev_b32 v36, 13, v36
    v_bfe_u32 v37, v1, 2, 3
    v_bfe_u32 v38, v1, 3, 2
    v_and_b32 v37, 1, v37
    v_lshl_add_u32 v36, v38, 11, v36
    v_lshl_add_u32 v36, v37, 10, v36
    v_and_b32 v37, 1, v1
    v_mul_u32_u24 v37, 496, v37
    v_bfe_u32 v38, v1, 1, 1
    v_lshl_add_u32 v37, v38, 9, v37
    v_add_u32 v36, v36, v37
    buffer_store_dwordx4 v[32:35], v36, s[32:35], s50 offen sc1
    s_add_u32 s51, s50, 0
    buffer_store_dwordx4 v[32:35], v2, s[32:35], s51 offen offset:0 sc1
    buffer_store_dwordx4 v[32:35], v2, s[32:35], s51 offen offset:1024 sc1
    buffer_store_dwordx4 v[32:35], v2, s[32:35], s51 offen offset:2048 sc1
    buffer_store_dwordx4 v[32:35], v2, s[32:35], s51 offen offset:3072 sc1
    s_add_u32 s51, s50, 4096
    buffer_store_dwordx4 v[32:35], v2, s[32:35], s51 offen offset:0 sc1
    buffer_store_dwordx4 v[32:35], v2, s[32:35], s51 offen offset:1024 sc1
    buffer_store_dwordx4 v[32:35], v2, s[32:35], s51 offen offset:2048 sc1
    buffer_store_dwordx4 v[32:35], v2, s[32:35], s51 offen offset:3072 sc1
    s_add_u32 s51, s50, 24576
    buffer_store_dwordx4 v[32:35], v2, s[32:35], s51 offen offset:0 sc1
    buffer_store_dwordx4 v[32:35], v2, s[32:35], s51 offen offset:1024 sc1
    buffer_store_dwordx4 v[32:35], v2, s[32:35], s51 offen offset:2048 sc1
    buffer_store_dwordx4 v[32:35], v2, s[32:35], s51 offen offset:3072 sc1
    s_add_u32 s51, s50, 28672
    buffer_store_dwordx4 v[32:35], v2, s[32:35], s51 offen offset:0 sc1
    buffer_store_dwordx4 v[32:35], v2, s[32:35], s51 offen offset:1024 sc1
    buffer_store_dwordx4 v[32:35], v2, s[32:35], s51 offen offset:2048 sc1
    buffer_store_dwordx4 v[32:35], v2, s[32:35], s51 offen offset:3072 sc1
    s_waitcnt lgkmcnt(0)
    s_barrier
    v_mov_b32 v22, 0
    v_mov_b32 v23, 0
    ds_read_b128 v[44:47], v6 offset:0
    ds_read_b128 v[48:51], v6 offset:96
    ds_read_b64 v[52:53], v7 offset:0
    ds_read_b64 v[54:55], v7 offset:96
    ds_read_u16_d16_hi v22, v8 offset:0
    ds_read_u16_d16_hi v23, v8 offset:96
    s_waitcnt lgkmcnt(5)
    v_lshlrev_b32 v136, 16, v44
    s_waitcnt lgkmcnt(4)
    v_lshlrev_b32 v137, 16, v48
    v_and_b32 v138, s47, v44
    v_and_b32 v139, s47, v48
    v_lshlrev_b32 v140, 16, v45
    v_lshlrev_b32 v141, 16, v49
    v_and_b32 v142, s47, v45
    v_and_b32 v143, s47, v49
    v_lshlrev_b32 v144, 16, v46
    v_lshlrev_b32 v145, 16, v50
    v_and_b32 v146, s47, v46
    v_and_b32 v147, s47, v50
    v_lshlrev_b32 v148, 16, v47
    v_lshlrev_b32 v149, 16, v51
    v_and_b32 v150, s47, v47
    v_and_b32 v151, s47, v51
    s_waitcnt lgkmcnt(3)
    v_lshlrev_b32 v152, 16, v52
    s_waitcnt lgkmcnt(2)
    v_lshlrev_b32 v153, 16, v54
    v_and_b32 v154, s47, v52
    v_and_b32 v155, s47, v54
    v_lshlrev_b32 v156, 16, v53
    v_lshlrev_b32 v157, 16, v55
    v_and_b32 v158, s47, v53
    v_and_b32 v159, s47, v55
    s_waitcnt lgkmcnt(1)
    v_mov_b32 v160, v22
    s_waitcnt lgkmcnt(0)
    v_mov_b32 v161, v23
    s_waitcnt vmcnt(17)
    v_lshlrev_b32 v24, 16, v168
    v_and_b32 v25, s47, v168
    v_lshlrev_b32 v26, 16, v172
    v_and_b32 v27, s47, v172
    v_lshlrev_b32 v28, 16, v169
    v_and_b32 v29, s47, v169
    v_lshlrev_b32 v30, 16, v173
    v_and_b32 v31, s47, v173
    v_lshlrev_b32 v32, 16, v170
    v_and_b32 v33, s47, v170
    v_lshlrev_b32 v34, 16, v174
    v_and_b32 v35, s47, v174
    v_lshlrev_b32 v36, 16, v171
    v_and_b32 v37, s47, v171
    v_lshlrev_b32 v38, 16, v175
    v_and_b32 v39, s47, v175
    s_mov_b32 s50, 0xbfb8aa3b
    v_mul_f32 v24, s50, v24
    v_mul_f32 v25, s50, v25
    v_mul_f32 v26, s50, v26
    v_mul_f32 v27, s50, v27
    v_mul_f32 v28, s50, v28
    v_mul_f32 v29, s50, v29
    v_mul_f32 v30, s50, v30
    v_mul_f32 v31, s50, v31
    v_mul_f32 v32, s50, v32
    v_mul_f32 v33, s50, v33
    v_mul_f32 v34, s50, v34
    v_mul_f32 v35, s50, v35
    v_mul_f32 v36, s50, v36
    v_mul_f32 v37, s50, v37
    v_mul_f32 v38, s50, v38
    v_mul_f32 v39, s50, v39
    s_lshl_b32 s50, s41, 22
    s_lshl_b32 s51, s44, 8
    s_add_u32 s50, s50, s51
    s_sub_u32 s52, s50, 256
    s_cmp_eq_u32 s42, 0
    s_cselect_b32 s52, s50, s52
    s_add_u32 s53, s50, 0
    s_add_u32 s55, s52, 2097152
    s_mov_b32 m0, 63680
    s_nop 0
    buffer_load_dwordx4 v165, s[28:31], s55 offen lds
    s_mov_b32 m0, 64704
    s_nop 0
    buffer_load_dwordx4 v166, s[28:31], s55 offen lds
    s_mov_b32 m0, 65728
    s_nop 0
    buffer_load_dwordx4 v164, s[28:31], s55 offen lds
    s_add_u32 s55, s53, 2097152
    s_mov_b32 m0, 75968
    s_nop 0
    buffer_load_dwordx4 v165, s[28:31], s55 offen lds
    s_mov_b32 m0, 76992
    s_nop 0
    buffer_load_dwordx4 v166, s[28:31], s55 offen lds
    s_mov_b32 m0, 78016
    s_nop 0
    buffer_load_dwordx4 v164, s[28:31], s55 offen lds
    s_waitcnt lgkmcnt(0)
    s_barrier
    s_branch L_common
.p2align 12
L_w2rest:
    v_lshlrev_b32 v30, 4, v0
    v_bfe_u32 v31, v0, 4, 3
    v_lshrrev_b32 v32, 1, v31
    v_mul_u32_u24 v32, 9248, v32
    v_and_b32 v31, 1, v31
    v_mul_u32_u24 v31, 8976, v31
    v_and_b32 v33, 15, v0
    v_lshlrev_b32 v33, 4, v33
    v_add3_u32 v31, v31, v32, v33
    v_mov_b32 v32, 0
    v_mov_b32 v33, 0
    v_mov_b32 v34, 0
    v_mov_b32 v35, 0
    ds_write_b128 v30, v[32:35] offset:0
    ds_write_b128 v30, v[32:35] offset:43200
    ds_write_b128 v30, v[32:35] offset:4096
    ds_write_b128 v30, v[32:35] offset:47296
    ds_write_b128 v30, v[32:35] offset:8192
    ds_write_b128 v30, v[32:35] offset:51392
    ds_write_b128 v31, v[32:35] offset:9248
    v_and_b32 v30, 15, v1
    v_lshrrev_b32 v31, 4, v1
    v_and_b32 v32, 31, v1
    v_mul_u32_u24 v32, 272, v32
    v_lshrrev_b32 v33, 5, v1
    v_lshl_add_u32 v3, v33, 4, v32
    s_mul_i32 s50, s40, 73728
    v_add_u32 v4, s50, v2
    v_mul_u32_u24 v34, 192, v30
    v_lshl_add_u32 v35, v31, 4, v34
    s_mul_i32 s50, s40, 12288
    s_add_u32 s50, s50, 69840
    v_add_u32 v6, s50, v35
    s_lshr_b32 s51, s40, 1
    s_and_b32 s52, s40, 1
    s_mul_i32 s50, s51, 61440
    s_lshl_b32 s53, s52, 5
    s_add_u32 s50, s50, s53
    s_add_u32 s50, s50, 57552
    v_lshl_add_u32 v35, v31, 3, v34
    v_add_u32 v7, s50, v35
    v_lshlrev_b32 v36, 2, v30
    v_mul_u32_u24 v37, 2176, v31
    v_add_u32 v37, v37, v36
    s_mul_i32 s50, s40, 9248
    s_add_u32 s50, s50, 9520
    v_add_u32 v9, s50, v37
    v_mul_u32_u24 v37, 1088, v31
    v_add_u32 v37, v37, v36
    s_mul_i32 s50, s51, 46240
    s_mul_i32 s53, s52, 4352
    s_add_u32 s50, s50, s53
    s_add_u32 s50, s50, 272
    s_cmp_eq_u32 s51, 0
    s_cselect_b32 s54, 0, 31
    s_cmp_lg_u32 s42, s54
    s_cselect_b32 s55, -1, 0
    v_add_u32 v37, s50, v37
    v_add_u32 v38, 55488, v36
    v_mov_b32 v39, s55
    v_cmp_ne_u32 vcc, 0, v39
    s_nop 1
    v_cndmask_b32 v10, v38, v37, vcc
    s_lshl_b32 s50, s40, 2
    v_add_u32 v37, s50, v31
    v_lshrrev_b32 v39, 1, v37
    v_and_b32 v31, 1, v37
    v_min_u32 v35, 5, v39
    v_mul_u32_u24 v35, 12288, v35
    v_add_u32 v35, v35, v34
    v_mul_u32_u24 v33, 66, v31
    v_add_u32 v35, v35, v33
    v_add_u32 v8, 57550, v35
    v_mul_u32_u24 v35, 9248, v39
    v_mul_u32_u24 v33, 8976, v31
    v_add3_u32 v35, v35, v33, v36
    v_cmp_gt_u32 vcc, 12, v37
    s_nop 0
    s_mov_b64 s[56:57], vcc
    s_cmp_eq_u32 s42, 0
    s_cselect_b32 s54, 0, 99
    v_cmp_ne_u32 vcc, s54, v39
    s_nop 0
    s_and_b64 s[56:57], s[56:57], vcc
    s_cmp_eq_u32 s42, 31
    s_cselect_b32 s54, 5, 99
    v_cmp_ne_u32 vcc, s54, v39
    s_nop 0
    s_and_b64 s[56:57], s[56:57], vcc
    s_cmp_eq_u32 s43, 0
    s_cselect_b32 s54, 0, 99
    v_cmp_ne_u32 vcc, s54, v31
    s_nop 0
    s_and_b64 s[56:57], s[56:57], vcc
    s_cmp_eq_u32 s43, 3
    s_cselect_b32 s54, 1, 99
    v_cmp_ne_u32 vcc, s54, v31
    s_nop 0
    s_and_b64 vcc, s[56:57], vcc
    v_cndmask_b32 v11, v38, v35, vcc
    s_waitcnt vmcnt(0)
    v_readfirstlane_b32 s61, v24
    v_mov_b32 v31, 131264
    s_cmp_lg_u32 s61, 0
    s_cbranch_scc1 L_non0_have
    global_load_dword v24, v25, s[24:25] offset:192 sc1
    s_branch L_non0_cont
L_non0_have:
    ds_write_b32 v31, v24 offset:12
L_non0_cont:
    s_mov_b64 exec, 0xffff
    v_perm_b32 v192, v132, v128, s75
    v_perm_b32 v193, v141, v137, s75
    v_perm_b32 v194, v150, v146, s75
    v_perm_b32 v195, v159, v155, s75
    buffer_store_dwordx4 v[192:195], v2, s[32:35], s72 offen offset:0 sc1
    v_perm_b32 v196, v133, v128, s76
    v_perm_b32 v197, v142, v137, s76
    v_perm_b32 v198, v151, v146, s76
    v_perm_b32 v199, v160, v155, s76
    buffer_store_dwordx4 v[196:199], v2, s[32:35], s72 offen offset:3072 sc1
    v_perm_b32 v200, v133, v129, s75
    v_perm_b32 v201, v142, v138, s75
    v_perm_b32 v202, v151, v147, s75
    v_perm_b32 v203, v160, v156, s75
    buffer_store_dwordx4 v[200:203], v2, s[32:35], s73 offen offset:2048 sc1
    v_perm_b32 v204, v134, v129, s76
    v_perm_b32 v205, v143, v138, s76
    v_perm_b32 v206, v152, v147, s76
    v_perm_b32 v207, v161, v156, s76
    buffer_store_dwordx4 v[204:207], v2, s[32:35], s72 offen offset:1024 sc1
    v_perm_b32 v208, v134, v130, s75
    v_perm_b32 v209, v143, v139, s75
    v_perm_b32 v210, v152, v148, s75
    v_perm_b32 v211, v161, v157, s75
    buffer_store_dwordx4 v[208:211], v2, s[32:35], s73 offen offset:0 sc1
    v_perm_b32 v212, v135, v130, s76
    v_perm_b32 v213, v144, v139, s76
    v_perm_b32 v214, v153, v148, s76
    v_perm_b32 v215, v162, v157, s76
    buffer_store_dwordx4 v[212:215], v2, s[32:35], s73 offen offset:3072 sc1
    v_perm_b32 v216, v135, v131, s75
    v_perm_b32 v217, v144, v140, s75
    v_perm_b32 v218, v153, v149, s75
    v_perm_b32 v219, v162, v158, s75
    buffer_store_dwordx4 v[216:219], v2, s[32:35], s72 offen offset:2048 sc1
    v_perm_b32 v220, v136, v131, s76
    v_perm_b32 v221, v145, v140, s76
    v_perm_b32 v222, v154, v149, s76
    v_perm_b32 v223, v163, v158, s76
    buffer_store_dwordx4 v[220:223], v2, s[32:35], s73 offen offset:1024 sc1
    v_perm_b32 v224, v136, v132, s75
    v_perm_b32 v225, v145, v141, s75
    v_perm_b32 v226, v154, v150, s75
    v_perm_b32 v227, v163, v159, s75
    buffer_store_dwordx4 v[224:227], v2, s[32:35], s74 offen offset:0 sc1
    s_mov_b64 exec, -1
    v_and_b32 v20, 15, v1
    v_lshlrev_b32 v20, 2, v20
    global_load_dword v168, v20, s[8:9] offset:0
    global_load_dword v172, v20, s[10:11] offset:0
    global_load_dword v169, v20, s[8:9] offset:64
    global_load_dword v173, v20, s[10:11] offset:64
    global_load_dword v170, v20, s[8:9] offset:128
    global_load_dword v174, v20, s[10:11] offset:128
    global_load_dword v171, v20, s[8:9] offset:192
    global_load_dword v175, v20, s[10:11] offset:192
    s_lshl_b32 s50, s41, 5
    s_add_u32 s50, s50, s42
    s_lshl_b32 s50, s50, 2
    s_add_u32 s46, s50, s43
    s_mov_b32 s47, 0xffff0000
    s_mov_b32 s48, 0xbf317218
    s_mov_b32 s49, 0xbf317218
    s_mov_b32 s36, s22
    s_mov_b32 s37, s23
    s_mov_b32 s38, 0x800000
    s_mov_b32 s39, 0x20000
    s_lshl_b32 s50, s46, 15
    s_lshl_b32 s51, s40, 11
    s_add_u32 s50, s50, s51
    s_add_u32 s71, s50, 1048576
    s_mov_b32 s72, s71
    s_add_u32 s73, s71, 8192
    s_add_u32 s74, s71, 16384
    s_add_u32 s75, s71, 24576
    s_sub_u32 s52, s71, 106496
    s_cmp_eq_u32 s42, 0
    s_cselect_b32 s76, s71, s52
    s_add_u32 s53, s71, 131072
    s_cmp_eq_u32 s42, 31
    s_cselect_b32 s77, s71, s53
    s_add_u32 s78, s51, 1048576
    s_lshl_b32 s50, s41, 22
    s_lshl_b32 s51, s40, 20
    s_add_u32 s50, s50, s51
    s_lshl_b32 s51, s44, 8
    s_add_u32 s50, s50, s51
    s_add_u32 s79, s50, s45
    s_lshl_b32 s50, s41, 2
    s_add_u32 s50, s50, s40
    s_mul_i32 s51, s50, 4608
    s_add_u32 s85, s51, 622592
    s_add_u32 s86, s85, 4096
    s_lshl_b32 s51, s50, 11
    s_add_u32 s51, s51, 589824
    s_lshl_b32 s52, s42, 2
    s_add_u32 s52, s52, s43
    s_lshl_b32 s52, s52, 3
    s_add_u32 s80, s51, s52
    s_and_b32 s52, s2, 1
    s_lshl_b32 s52, s52, 10
    s_add_u32 s81, s51, s52
    s_mov_b64 s[82:83], 0x3f
    s_lshl_b32 s52, s42, 1
    s_sub_u32 s52, s52, 2
    s_lshl_b64 s[82:83], s[82:83], s52
    s_cmp_eq_u32 s42, 0
    s_cselect_b64 s[82:83], 15, s[82:83]
    v_and_b32 v56, 31, v1
    v_lshrrev_b32 v57, 5, v1
    s_lshl_b32 s50, s40, 4
    v_lshl_add_u32 v58, v57, 3, s50
    v_mul_u32_u24 v59, 272, v56
    v_add_u32 v59, v59, v58
    v_add_u32 v12, 272, v59
    v_add_u32 v60, 55488, v58
    s_cmp_lg_u32 s42, 0
    s_cselect_b32 s54, -1, 0
    v_mov_b32 v61, s54
    v_cmp_ne_u32 vcc, 0, v61
    s_nop 1
    v_cndmask_b32 v13, v60, v12, vcc
    v_add_u32 v62, 46240, v12
    s_cmp_lg_u32 s42, 31
    s_cselect_b32 s54, -1, 0
    v_mov_b32 v61, s54
    v_cmp_ne_u32 vcc, 0, v61
    s_nop 1
    v_cndmask_b32 v14, v60, v62, vcc
    v_lshrrev_b32 v61, 1, v56
    v_and_b32 v62, 1, v56
    v_mul_u32_u24 v63, 9248, v61
    v_mul_u32_u24 v20, 8976, v62
    v_add3_u32 v63, v63, v20, v58
    v_cmp_gt_u32 vcc, 12, v56
    s_nop 0
    s_mov_b64 s[56:57], vcc
    s_cmp_eq_u32 s42, 0
    s_cselect_b32 s54, 0, 99
    v_cmp_ne_u32 vcc, s54, v61
    s_nop 0
    s_and_b64 s[56:57], s[56:57], vcc
    s_cmp_eq_u32 s42, 31
    s_cselect_b32 s54, 5, 99
    v_cmp_ne_u32 vcc, s54, v61
    s_nop 0
    s_and_b64 s[56:57], s[56:57], vcc
    s_cmp_eq_u32 s43, 0
    s_cselect_b32 s54, 0, 99
    v_cmp_ne_u32 vcc, s54, v62
    s_nop 0
    s_and_b64 s[56:57], s[56:57], vcc
    s_cmp_eq_u32 s43, 3
    s_cselect_b32 s54, 1, 99
    v_cmp_ne_u32 vcc, s54, v62
    s_nop 0
    s_and_b64 s[56:57], s[56:57], vcc
    s_mov_b64 vcc, s[56:57]
    v_cndmask_b32 v15, v60, v63, vcc
    v_cmp_eq_u32 vcc, 0, v61
    s_nop 1
    v_cndmask_b32 v63, 0, -4, vcc
    v_add_u32 v20, -1, v61
    v_cndmask_b32 v20, v20, 3, vcc
    v_cmp_eq_u32 vcc, 5, v61
    s_nop 1
    v_cndmask_b32 v63, v63, 4, vcc
    v_cndmask_b32 v20, v20, 0, vcc
    v_lshl_add_u32 v63, v62, 1, v63
    v_add_u32 v63, -1, v63
    v_add_u32 v63, s46, v63
    v_lshlrev_b32 v63, 15, v63
    v_lshl_add_u32 v63, v20, 13, v63
    v_lshlrev_b32 v20, 5, v57
    v_xor_b32 v21, 1, v62
    v_mul_u32_u24 v21, 31, v21
    v_add_u32 v20, v20, v21
    v_lshl_add_u32 v63, v20, 4, v63
    s_lshl_b32 s54, s46, 15
    v_mov_b32 v20, s54
    s_mov_b64 vcc, s[56:57]
    v_cndmask_b32 v16, v20, v63, vcc
    v_lshlrev_b32 v59, 15, v56
    v_lshl_add_u32 v17, v57, 4, v59
    v_and_b32 v59, 15, v1
    v_lshlrev_b32 v59, 15, v59
    v_lshl_add_u32 v17, v57, 4, v59
    v_bfe_u32 v59, v1, 4, 1
    v_lshl_add_u32 v17, v59, 5, v17
    s_mul_i32 s50, s40, 3072
    s_add_u32 s50, s50, 57552
    v_mul_u32_u24 v59, 96, v56
    v_lshl_add_u32 v59, v57, 3, v59
    v_add_u32 v18, s50, v59
    v_cmp_eq_u32 vcc, 0, v56
    v_cmp_eq_u32 s[56:57], 31, v56
    s_nop 0
    s_or_b64 vcc, vcc, s[56:57]
    v_mov_b32 v59, 1073741824
    v_cndmask_b32 v5, v59, v2, vcc
    s_sub_i32 s53, s45, 16
    s_movk_i32 s54, 240
    s_lshl_b32 s55, s40, 1
    s_lshr_b32 s55, 0x18, s55
    s_and_b32 s55, s55, 3
    s_add_u32 s56, s55, 0
    s_cmp_ge_u32 s56, 3
    s_cselect_b32 s57, 3, 0
    s_sub_u32 s56, s56, s57
    s_lshl_b32 s56, s56, 6
    v_add_u32 v30, s56, v1
    v_mul_u32_u24 v31, 171, v30
    v_lshrrev_b32 v31, 10, v31
    v_mul_u32_u24 v32, 6, v31
    v_sub_u32 v32, v30, v32
    v_lshl_add_u32 v32, v32, 4, s53
    v_med3_i32 v32, v32, 0, s54
    v_lshl_add_u32 v164, v31, 15, v32
    s_add_u32 s56, s55, 1
    s_cmp_ge_u32 s56, 3
    s_cselect_b32 s57, 3, 0
    s_sub_u32 s56, s56, s57
    s_lshl_b32 s56, s56, 6
    v_add_u32 v30, s56, v1
    v_mul_u32_u24 v31, 171, v30
    v_lshrrev_b32 v31, 10, v31
    v_mul_u32_u24 v32, 6, v31
    v_sub_u32 v32, v30, v32
    v_lshl_add_u32 v32, v32, 4, s53
    v_med3_i32 v32, v32, 0, s54
    v_lshl_add_u32 v165, v31, 15, v32
    s_add_u32 s56, s55, 2
    s_cmp_ge_u32 s56, 3
    s_cselect_b32 s57, 3, 0
    s_sub_u32 s56, s56, s57
    s_lshl_b32 s56, s56, 6
    v_add_u32 v30, s56, v1
    v_mul_u32_u24 v31, 171, v30
    v_lshrrev_b32 v31, 10, v31
    v_mul_u32_u24 v32, 6, v31
    v_sub_u32 v32, v30, v32
    v_lshl_add_u32 v32, v32, 4, s53
    v_med3_i32 v32, v32, 0, s54
    v_lshl_add_u32 v166, v31, 15, v32
    s_lshl_b32 s52, s41, 22
    s_lshl_b32 s53, s44, 8
    s_add_u32 s52, s52, s53
    s_add_u32 s52, s52, 3145472
    s_mul_i32 s50, s40, 5
    s_cmp_eq_u32 s42, 0
    s_cselect_b32 s54, 1, 0
    s_cmp_eq_u32 s42, 31
    s_cselect_b32 s55, 4, 5
    v_add_u32 v30, s50, v1
    v_mov_b32 v33, s55
    v_cmp_le_u32 vcc, 18, v30
    s_nop 1
    v_cndmask_b32 v31, 0, 3, vcc
    v_sub_u32 v30, v30, v31
    v_mul_u32_u24 v31, 43, v30
    v_lshrrev_b32 v31, 7, v31
    v_mul_u32_u24 v32, 3, v31
    v_sub_u32 v32, v30, v32
    v_lshlrev_b32 v32, 10, v32
    v_mul_u32_u24 v30, 12288, v31
    v_med3_u32 v31, v31, s54, v33
    v_add_u32 v32, 63680, v32
    v_lshl_add_u32 v31, v31, 8, s52
    v_add_u32 v32, v32, v30
    v_readlane_b32 s62, v31, 0
    v_readlane_b32 s67, v32, 0
    v_readlane_b32 s63, v31, 1
    v_readlane_b32 s68, v32, 1
    v_readlane_b32 s64, v31, 2
    v_readlane_b32 s71, v32, 2
    v_readlane_b32 s65, v31, 3
    v_readlane_b32 s84, v32, 3
    v_readlane_b32 s66, v31, 4
    v_readlane_b32 s96, v32, 4
    v_mov_b32 v56, 0
    v_mov_b32 v57, 0
    v_mov_b32 v58, 0
    v_mov_b32 v59, 0
    s_waitcnt vmcnt(8)
    s_mov_b32 s70, 0
L_non:
    v_readfirstlane_b32 s50, v24
    s_add_u32 s70, s70, 1
    s_cmp_lg_u32 s50, 0
    s_cbranch_scc1 L_non_ok
    s_cmp_ge_u32 s70, 20000
    s_cbranch_scc1 L_non_ok
    s_sleep 2
    global_load_dword v24, v25, s[24:25] offset:192 sc1
    s_waitcnt vmcnt(0)
    s_branch L_non
L_non_ok:
    v_mov_b32 v31, 131264
    v_mov_b32 v25, v24
    ds_write_b64 v31, v[24:25] offset:8
    s_lshl_b32 s50, s2, 2
    s_add_u32 s50, s50, 610304
    s_waitcnt vmcnt(0)
    s_cmp_lt_u32 s2, 36
    s_cbranch_scc1 L_nofl
    s_mov_b64 exec, 1
    buffer_store_dword v24, off, s[32:35], s50 sc1
    s_mov_b64 exec, -1
L_nofl:
L_w2tail:
    s_nop 1
    s_waitcnt lgkmcnt(0)
    s_barrier
    v_mov_b32 v22, 0
    v_mov_b32 v23, 0
    ds_read_b128 v[44:47], v6 offset:0
    ds_read_b128 v[48:51], v6 offset:96
    ds_read_b64 v[52:53], v7 offset:0
    ds_read_b64 v[54:55], v7 offset:96
    ds_read_u16_d16_hi v22, v8 offset:0
    ds_read_u16_d16_hi v23, v8 offset:96
    s_waitcnt lgkmcnt(5)
    v_lshlrev_b32 v136, 16, v44
    s_waitcnt lgkmcnt(4)
    v_lshlrev_b32 v137, 16, v48
    v_and_b32 v138, s47, v44
    v_and_b32 v139, s47, v48
    v_lshlrev_b32 v140, 16, v45
    v_lshlrev_b32 v141, 16, v49
    v_and_b32 v142, s47, v45
    v_and_b32 v143, s47, v49
    v_lshlrev_b32 v144, 16, v46
    v_lshlrev_b32 v145, 16, v50
    v_and_b32 v146, s47, v46
    v_and_b32 v147, s47, v50
    v_lshlrev_b32 v148, 16, v47
    v_lshlrev_b32 v149, 16, v51
    v_and_b32 v150, s47, v47
    v_and_b32 v151, s47, v51
    s_waitcnt lgkmcnt(3)
    v_lshlrev_b32 v152, 16, v52
    s_waitcnt lgkmcnt(2)
    v_lshlrev_b32 v153, 16, v54
    v_and_b32 v154, s47, v52
    v_and_b32 v155, s47, v54
    v_lshlrev_b32 v156, 16, v53
    v_lshlrev_b32 v157, 16, v55
    v_and_b32 v158, s47, v53
    v_and_b32 v159, s47, v55
    s_waitcnt lgkmcnt(1)
    v_mov_b32 v160, v22
    s_waitcnt lgkmcnt(0)
    v_mov_b32 v161, v23
    v_lshlrev_b32 v24, 16, v168
    v_and_b32 v25, s47, v168
    v_lshlrev_b32 v26, 16, v172
    v_and_b32 v27, s47, v172
    v_lshlrev_b32 v28, 16, v169
    v_and_b32 v29, s47, v169
    v_lshlrev_b32 v30, 16, v173
    v_and_b32 v31, s47, v173
    v_lshlrev_b32 v32, 16, v170
    v_and_b32 v33, s47, v170
    v_lshlrev_b32 v34, 16, v174
    v_and_b32 v35, s47, v174
    v_lshlrev_b32 v36, 16, v171
    v_and_b32 v37, s47, v171
    v_lshlrev_b32 v38, 16, v175
    v_and_b32 v39, s47, v175
    s_mov_b32 s50, 0xbfb8aa3b
    v_mul_f32 v24, s50, v24
    v_mul_f32 v25, s50, v25
    v_mul_f32 v26, s50, v26
    v_mul_f32 v27, s50, v27
    v_mul_f32 v28, s50, v28
    v_mul_f32 v29, s50, v29
    v_mul_f32 v30, s50, v30
    v_mul_f32 v31, s50, v31
    v_mul_f32 v32, s50, v32
    v_mul_f32 v33, s50, v33
    v_mul_f32 v34, s50, v34
    v_mul_f32 v35, s50, v35
    v_mul_f32 v36, s50, v36
    v_mul_f32 v37, s50, v37
    v_mul_f32 v38, s50, v38
    v_mul_f32 v39, s50, v39
    s_lshl_b32 s50, s41, 22
    s_lshl_b32 s51, s44, 8
    s_add_u32 s50, s50, s51
    s_add_u32 s52, s50, 256
    s_add_u32 s53, s50, 512
    s_add_u32 s55, s52, 2097152
    s_mov_b32 m0, 88256
    s_nop 0
    buffer_load_dwordx4 v166, s[28:31], s55 offen lds
    s_mov_b32 m0, 89280
    s_nop 0
    buffer_load_dwordx4 v164, s[28:31], s55 offen lds
    s_mov_b32 m0, 90304
    s_nop 0
    buffer_load_dwordx4 v165, s[28:31], s55 offen lds
    s_add_u32 s55, s53, 2097152
    s_mov_b32 m0, 100544
    s_nop 0
    buffer_load_dwordx4 v166, s[28:31], s55 offen lds
    s_mov_b32 m0, 101568
    s_nop 0
    buffer_load_dwordx4 v164, s[28:31], s55 offen lds
    s_mov_b32 m0, 102592
    s_nop 0
    buffer_load_dwordx4 v165, s[28:31], s55 offen lds
    s_waitcnt lgkmcnt(0)
    s_barrier
    s_branch L_common
.p2align 12
L_w3rest:
    v_lshlrev_b32 v30, 4, v0
    v_bfe_u32 v31, v0, 4, 3
    v_lshrrev_b32 v32, 1, v31
    v_mul_u32_u24 v32, 9248, v32
    v_and_b32 v31, 1, v31
    v_mul_u32_u24 v31, 8976, v31
    v_and_b32 v33, 15, v0
    v_lshlrev_b32 v33, 4, v33
    v_add3_u32 v31, v31, v32, v33
    v_mov_b32 v32, 0
    v_mov_b32 v33, 0
    v_mov_b32 v34, 0
    v_mov_b32 v35, 0
    ds_write_b128 v30, v[32:35] offset:0
    ds_write_b128 v30, v[32:35] offset:43200
    ds_write_b128 v30, v[32:35] offset:4096
    ds_write_b128 v30, v[32:35] offset:47296
    ds_write_b128 v30, v[32:35] offset:8192
    ds_write_b128 v30, v[32:35] offset:51392
    ds_write_b128 v31, v[32:35] offset:9248
    v_and_b32 v30, 15, v1
    v_lshrrev_b32 v31, 4, v1
    v_and_b32 v32, 31, v1
    v_mul_u32_u24 v32, 272, v32
    v_lshrrev_b32 v33, 5, v1
    v_lshl_add_u32 v3, v33, 4, v32
    s_mul_i32 s50, s40, 73728
    v_add_u32 v4, s50, v2
    v_mul_u32_u24 v34, 192, v30
    v_lshl_add_u32 v35, v31, 4, v34
    s_mul_i32 s50, s40, 12288
    s_add_u32 s50, s50, 69840
    v_add_u32 v6, s50, v35
    s_lshr_b32 s51, s40, 1
    s_and_b32 s52, s40, 1
    s_mul_i32 s50, s51, 61440
    s_lshl_b32 s53, s52, 5
    s_add_u32 s50, s50, s53
    s_add_u32 s50, s50, 57552
    v_lshl_add_u32 v35, v31, 3, v34
    v_add_u32 v7, s50, v35
    v_lshlrev_b32 v36, 2, v30
    v_mul_u32_u24 v37, 2176, v31
    v_add_u32 v37, v37, v36
    s_mul_i32 s50, s40, 9248
    s_add_u32 s50, s50, 9520
    v_add_u32 v9, s50, v37
    v_mul_u32_u24 v37, 1088, v31
    v_add_u32 v37, v37, v36
    s_mul_i32 s50, s51, 46240
    s_mul_i32 s53, s52, 4352
    s_add_u32 s50, s50, s53
    s_add_u32 s50, s50, 272
    s_cmp_eq_u32 s51, 0
    s_cselect_b32 s54, 0, 31
    s_cmp_lg_u32 s42, s54
    s_cselect_b32 s55, -1, 0
    v_add_u32 v37, s50, v37
    v_add_u32 v38, 55488, v36
    v_mov_b32 v39, s55
    v_cmp_ne_u32 vcc, 0, v39
    s_nop 1
    v_cndmask_b32 v10, v38, v37, vcc
    s_lshl_b32 s50, s40, 2
    v_add_u32 v37, s50, v31
    v_lshrrev_b32 v39, 1, v37
    v_and_b32 v31, 1, v37
    v_min_u32 v35, 5, v39
    v_mul_u32_u24 v35, 12288, v35
    v_add_u32 v35, v35, v34
    v_mul_u32_u24 v33, 66, v31
    v_add_u32 v35, v35, v33
    v_add_u32 v8, 57550, v35
    v_mul_u32_u24 v35, 9248, v39
    v_mul_u32_u24 v33, 8976, v31
    v_add3_u32 v35, v35, v33, v36
    v_cmp_gt_u32 vcc, 12, v37
    s_nop 0
    s_mov_b64 s[56:57], vcc
    s_cmp_eq_u32 s42, 0
    s_cselect_b32 s54, 0, 99
    v_cmp_ne_u32 vcc, s54, v39
    s_nop 0
    s_and_b64 s[56:57], s[56:57], vcc
    s_cmp_eq_u32 s42, 31
    s_cselect_b32 s54, 5, 99
    v_cmp_ne_u32 vcc, s54, v39
    s_nop 0
    s_and_b64 s[56:57], s[56:57], vcc
    s_cmp_eq_u32 s43, 0
    s_cselect_b32 s54, 0, 99
    v_cmp_ne_u32 vcc, s54, v31
    s_nop 0
    s_and_b64 s[56:57], s[56:57], vcc
    s_cmp_eq_u32 s43, 3
    s_cselect_b32 s54, 1, 99
    v_cmp_ne_u32 vcc, s54, v31
    s_nop 0
    s_and_b64 vcc, s[56:57], vcc
    v_cndmask_b32 v11, v38, v35, vcc
    s_lshl_b32 s50, s41, 5
    s_add_u32 s50, s50, s42
    s_lshl_b32 s50, s50, 2
    s_add_u32 s46, s50, s43
    s_mov_b32 s47, 0xffff0000
    s_mov_b32 s48, 0xbf317218
    s_mov_b32 s49, 0xbf317218
    s_mov_b32 s36, s22
    s_mov_b32 s37, s23
    s_mov_b32 s38, 0x800000
    s_mov_b32 s39, 0x20000
    s_lshl_b32 s50, s46, 15
    s_lshl_b32 s51, s40, 11
    s_add_u32 s50, s50, s51
    s_add_u32 s71, s50, 1048576
    s_mov_b32 s72, s71
    s_add_u32 s73, s71, 8192
    s_add_u32 s74, s71, 16384
    s_add_u32 s75, s71, 24576
    s_sub_u32 s52, s71, 106496
    s_cmp_eq_u32 s42, 0
    s_cselect_b32 s76, s71, s52
    s_add_u32 s53, s71, 131072
    s_cmp_eq_u32 s42, 31
    s_cselect_b32 s77, s71, s53
    s_add_u32 s78, s51, 1048576
    s_lshl_b32 s50, s41, 22
    s_lshl_b32 s51, s40, 20
    s_add_u32 s50, s50, s51
    s_lshl_b32 s51, s44, 8
    s_add_u32 s50, s50, s51
    s_add_u32 s79, s50, s45
    s_lshl_b32 s50, s41, 2
    s_add_u32 s50, s50, s40
    s_mul_i32 s51, s50, 4608
    s_add_u32 s85, s51, 622592
    s_add_u32 s86, s85, 4096
    s_lshl_b32 s51, s50, 11
    s_add_u32 s51, s51, 589824
    s_lshl_b32 s52, s42, 2
    s_add_u32 s52, s52, s43
    s_lshl_b32 s52, s52, 3
    s_add_u32 s80, s51, s52
    s_and_b32 s52, s2, 1
    s_lshl_b32 s52, s52, 10
    s_add_u32 s81, s51, s52
    s_mov_b64 s[82:83], 0x3f
    s_lshl_b32 s52, s42, 1
    s_sub_u32 s52, s52, 2
    s_lshl_b64 s[82:83], s[82:83], s52
    s_cmp_eq_u32 s42, 0
    s_cselect_b64 s[82:83], 15, s[82:83]
    v_and_b32 v56, 31, v1
    v_lshrrev_b32 v57, 5, v1
    s_lshl_b32 s50, s40, 4
    v_lshl_add_u32 v58, v57, 3, s50
    v_mul_u32_u24 v59, 272, v56
    v_add_u32 v59, v59, v58
    v_add_u32 v12, 272, v59
    v_add_u32 v60, 55488, v58
    s_cmp_lg_u32 s42, 0
    s_cselect_b32 s54, -1, 0
    v_mov_b32 v61, s54
    v_cmp_ne_u32 vcc, 0, v61
    s_nop 1
    v_cndmask_b32 v13, v60, v12, vcc
    v_add_u32 v62, 46240, v12
    s_cmp_lg_u32 s42, 31
    s_cselect_b32 s54, -1, 0
    v_mov_b32 v61, s54
    v_cmp_ne_u32 vcc, 0, v61
    s_nop 1
    v_cndmask_b32 v14, v60, v62, vcc
    v_lshrrev_b32 v61, 1, v56
    v_and_b32 v62, 1, v56
    v_mul_u32_u24 v63, 9248, v61
    v_mul_u32_u24 v20, 8976, v62
    v_add3_u32 v63, v63, v20, v58
    v_cmp_gt_u32 vcc, 12, v56
    s_nop 0
    s_mov_b64 s[56:57], vcc
    s_cmp_eq_u32 s42, 0
    s_cselect_b32 s54, 0, 99
    v_cmp_ne_u32 vcc, s54, v61
    s_nop 0
    s_and_b64 s[56:57], s[56:57], vcc
    s_cmp_eq_u32 s42, 31
    s_cselect_b32 s54, 5, 99
    v_cmp_ne_u32 vcc, s54, v61
    s_nop 0
    s_and_b64 s[56:57], s[56:57], vcc
    s_cmp_eq_u32 s43, 0
    s_cselect_b32 s54, 0, 99
    v_cmp_ne_u32 vcc, s54, v62
    s_nop 0
    s_and_b64 s[56:57], s[56:57], vcc
    s_cmp_eq_u32 s43, 3
    s_cselect_b32 s54, 1, 99
    v_cmp_ne_u32 vcc, s54, v62
    s_nop 0
    s_and_b64 s[56:57], s[56:57], vcc
    s_mov_b64 vcc, s[56:57]
    v_cndmask_b32 v15, v60, v63, vcc
    v_cmp_eq_u32 vcc, 0, v61
    s_nop 1
    v_cndmask_b32 v63, 0, -4, vcc
    v_add_u32 v20, -1, v61
    v_cndmask_b32 v20, v20, 3, vcc
    v_cmp_eq_u32 vcc, 5, v61
    s_nop 1
    v_cndmask_b32 v63, v63, 4, vcc
    v_cndmask_b32 v20, v20, 0, vcc
    v_lshl_add_u32 v63, v62, 1, v63
    v_add_u32 v63, -1, v63
    v_add_u32 v63, s46, v63
    v_lshlrev_b32 v63, 15, v63
    v_lshl_add_u32 v63, v20, 13, v63
    v_lshlrev_b32 v20, 5, v57
    v_xor_b32 v21, 1, v62
    v_mul_u32_u24 v21, 31, v21
    v_add_u32 v20, v20, v21
    v_lshl_add_u32 v63, v20, 4, v63
    s_lshl_b32 s54, s46, 15
    v_mov_b32 v20, s54
    s_mov_b64 vcc, s[56:57]
    v_cndmask_b32 v16, v20, v63, vcc
    v_lshlrev_b32 v59, 15, v56
    v_lshl_add_u32 v17, v57, 4, v59
    v_and_b32 v59, 15, v1
    v_lshlrev_b32 v59, 15, v59
    v_lshl_add_u32 v17, v57, 4, v59
    v_bfe_u32 v59, v1, 4, 1
    v_lshl_add_u32 v17, v59, 5, v17
    s_mul_i32 s50, s40, 3072
    s_add_u32 s50, s50, 57552
    v_mul_u32_u24 v59, 96, v56
    v_lshl_add_u32 v59, v57, 3, v59
    v_add_u32 v18, s50, v59
    v_cmp_eq_u32 vcc, 0, v56
    v_cmp_eq_u32 s[56:57], 31, v56
    s_nop 0
    s_or_b64 vcc, vcc, s[56:57]
    v_mov_b32 v59, 1073741824
    v_cndmask_b32 v5, v59, v2, vcc
    v_mov_b32 v56, 0
    v_mov_b32 v57, 0
    v_mov_b32 v58, 0
    v_mov_b32 v59, 0
    s_waitcnt vmcnt(0)
    s_add_u32 s50, s63, 1048576
    s_mov_b32 m0, 72896
    s_nop 0
    buffer_load_dwordx4 v164, s[28:31], s50 offen lds
    s_mov_b32 m0, 73920
    s_nop 0
    buffer_load_dwordx4 v165, s[28:31], s50 offen lds
    s_mov_b32 m0, 74944
    s_nop 0
    buffer_load_dwordx4 v166, s[28:31], s50 offen lds
    s_add_u32 s50, s64, 1048576
    s_mov_b32 m0, 85184
    s_nop 0
    buffer_load_dwordx4 v164, s[28:31], s50 offen lds
    s_mov_b32 m0, 86208
    s_nop 0
    buffer_load_dwordx4 v165, s[28:31], s50 offen lds
    s_mov_b32 m0, 87232
    s_nop 0
    buffer_load_dwordx4 v166, s[28:31], s50 offen lds
    s_add_u32 s50, s65, 1048576
    s_mov_b32 m0, 97472
    s_nop 0
    buffer_load_dwordx4 v164, s[28:31], s50 offen lds
    s_mov_b32 m0, 98496
    s_nop 0
    buffer_load_dwordx4 v165, s[28:31], s50 offen lds
    s_mov_b32 m0, 99520
    s_nop 0
    buffer_load_dwordx4 v166, s[28:31], s50 offen lds
    s_add_u32 s50, s66, 1048576
    s_mov_b32 m0, 109760
    s_nop 0
    buffer_load_dwordx4 v164, s[28:31], s50 offen lds
    s_mov_b32 m0, 110784
    s_nop 0
    buffer_load_dwordx4 v165, s[28:31], s50 offen lds
    s_mov_b32 m0, 111808
    s_nop 0
    buffer_load_dwordx4 v166, s[28:31], s50 offen lds
    s_add_u32 s50, s62, 1048576
    s_mov_b32 m0, 60608
    s_nop 0
    buffer_load_dwordx4 v164, s[28:31], s50 offen lds
    s_mov_b32 m0, 61632
    s_nop 0
    buffer_load_dwordx4 v165, s[28:31], s50 offen lds
    s_mov_b32 m0, 62656
    s_nop 0
    buffer_load_dwordx4 v166, s[28:31], s50 offen lds
    s_add_u32 s50, s67, 1048576
    s_mov_b32 m0, 122048
    s_nop 0
    buffer_load_dwordx4 v164, s[28:31], s50 offen lds
    s_mov_b32 m0, 123072
    s_nop 0
    buffer_load_dwordx4 v165, s[28:31], s50 offen lds
    s_mov_b32 m0, 124096
    s_nop 0
    buffer_load_dwordx4 v166, s[28:31], s50 offen lds
    s_lshl_b32 s52, s41, 22
    s_lshl_b32 s53, s44, 8
    s_add_u32 s52, s52, s53
    s_add_u32 s52, s52, 3145472
    s_mul_i32 s50, s40, 5
    s_cmp_eq_u32 s42, 0
    s_cselect_b32 s54, 1, 0
    s_cmp_eq_u32 s42, 31
    s_cselect_b32 s55, 4, 5
    v_add_u32 v30, s50, v1
    v_mov_b32 v33, s55
    v_cmp_le_u32 vcc, 18, v30
    s_nop 1
    v_cndmask_b32 v31, 0, 3, vcc
    v_sub_u32 v30, v30, v31
    v_mul_u32_u24 v31, 43, v30
    v_lshrrev_b32 v31, 7, v31
    v_mul_u32_u24 v32, 3, v31
    v_sub_u32 v32, v30, v32
    v_lshlrev_b32 v32, 10, v32
    v_mul_u32_u24 v30, 12288, v31
    v_med3_u32 v31, v31, s54, v33
    v_add_u32 v32, 63680, v32
    v_lshl_add_u32 v31, v31, 8, s52
    v_add_u32 v32, v32, v30
    v_readlane_b32 s62, v31, 0
    v_readlane_b32 s67, v32, 0
    v_readlane_b32 s63, v31, 1
    v_readlane_b32 s68, v32, 1
    v_readlane_b32 s64, v31, 2
    v_readlane_b32 s71, v32, 2
    v_readlane_b32 s65, v31, 3
    v_readlane_b32 s84, v32, 3
    v_readlane_b32 s66, v31, 4
    v_readlane_b32 s96, v32, 4
    s_waitcnt lgkmcnt(0)
    s_barrier
    v_mov_b32 v22, 0
    v_mov_b32 v23, 0
    ds_read_b128 v[44:47], v6 offset:0
    ds_read_b128 v[48:51], v6 offset:96
    ds_read_b64 v[52:53], v7 offset:0
    ds_read_b64 v[54:55], v7 offset:96
    ds_read_u16_d16_hi v22, v8 offset:0
    ds_read_u16_d16_hi v23, v8 offset:96
    s_waitcnt lgkmcnt(5)
    v_lshlrev_b32 v136, 16, v44
    s_waitcnt lgkmcnt(4)
    v_lshlrev_b32 v137, 16, v48
    v_and_b32 v138, s47, v44
    v_and_b32 v139, s47, v48
    v_lshlrev_b32 v140, 16, v45
    v_lshlrev_b32 v141, 16, v49
    v_and_b32 v142, s47, v45
    v_and_b32 v143, s47, v49
    v_lshlrev_b32 v144, 16, v46
    v_lshlrev_b32 v145, 16, v50
    v_and_b32 v146, s47, v46
    v_and_b32 v147, s47, v50
    v_lshlrev_b32 v148, 16, v47
    v_lshlrev_b32 v149, 16, v51
    v_and_b32 v150, s47, v47
    v_and_b32 v151, s47, v51
    s_waitcnt lgkmcnt(3)
    v_lshlrev_b32 v152, 16, v52
    s_waitcnt lgkmcnt(2)
    v_lshlrev_b32 v153, 16, v54
    v_and_b32 v154, s47, v52
    v_and_b32 v155, s47, v54
    v_lshlrev_b32 v156, 16, v53
    v_lshlrev_b32 v157, 16, v55
    v_and_b32 v158, s47, v53
    v_and_b32 v159, s47, v55
    s_waitcnt lgkmcnt(1)
    v_mov_b32 v160, v22
    s_waitcnt lgkmcnt(0)
    v_mov_b32 v161, v23
    v_lshlrev_b32 v24, 16, v168
    v_and_b32 v25, s47, v168
    v_lshlrev_b32 v26, 16, v172
    v_and_b32 v27, s47, v172
    v_lshlrev_b32 v28, 16, v169
    v_and_b32 v29, s47, v169
    v_lshlrev_b32 v30, 16, v173
    v_and_b32 v31, s47, v173
    v_lshlrev_b32 v32, 16, v170
    v_and_b32 v33, s47, v170
    v_lshlrev_b32 v34, 16, v174
    v_and_b32 v35, s47, v174
    v_lshlrev_b32 v36, 16, v171
    v_and_b32 v37, s47, v171
    v_lshlrev_b32 v38, 16, v175
    v_and_b32 v39, s47, v175
    s_mov_b32 s50, 0xbfb8aa3b
    v_mul_f32 v24, s50, v24
    v_mul_f32 v25, s50, v25
    v_mul_f32 v26, s50, v26
    v_mul_f32 v27, s50, v27
    v_mul_f32 v28, s50, v28
    v_mul_f32 v29, s50, v29
    v_mul_f32 v30, s50, v30
    v_mul_f32 v31, s50, v31
    v_mul_f32 v32, s50, v32
    v_mul_f32 v33, s50, v33
    v_mul_f32 v34, s50, v34
    v_mul_f32 v35, s50, v35
    v_mul_f32 v36, s50, v36
    v_mul_f32 v37, s50, v37
    v_mul_f32 v38, s50, v38
    v_mul_f32 v39, s50, v39
    s_lshl_b32 s50, s41, 22
    s_lshl_b32 s51, s44, 8
    s_add_u32 s50, s50, s51
    s_add_u32 s52, s50, 768
    s_add_u32 s53, s50, 1024
    s_add_u32 s54, s50, 768
    s_cmp_eq_u32 s42, 31
    s_cselect_b32 s53, s54, s53
    s_add_u32 s55, s52, 2097152
    s_mov_b32 m0, 112832
    s_nop 0
    buffer_load_dwordx4 v164, s[28:31], s55 offen lds
    s_mov_b32 m0, 113856
    s_nop 0
    buffer_load_dwordx4 v165, s[28:31], s55 offen lds
    s_mov_b32 m0, 114880
    s_nop 0
    buffer_load_dwordx4 v166, s[28:31], s55 offen lds
    s_add_u32 s55, s53, 2097152
    s_mov_b32 m0, 125120
    s_nop 0
    buffer_load_dwordx4 v164, s[28:31], s55 offen lds
    s_mov_b32 m0, 126144
    s_nop 0
    buffer_load_dwordx4 v165, s[28:31], s55 offen lds
    s_mov_b32 m0, 127168
    s_nop 0
    buffer_load_dwordx4 v166, s[28:31], s55 offen lds
    s_waitcnt lgkmcnt(0)
    s_barrier
    s_branch L_common
.p2align 12
L_w3e:
    s_mov_b32 s47, 0xffff0000
    s_waitcnt vmcnt(50)
    v_lshlrev_b32 v29, 16, v29
    v_mul_f32 v38, 0xbfb8aa3b, v29
    v_exp_f32 v38, v38
    s_nop 0
    v_add_f32 v38, 1.0, v38
    v_rcp_f32 v38, v38
    s_nop 0
    v_mul_f32 v29, v29, v38
    v_mov_b32 v104, 0
    v_mov_b32 v105, 0
    v_mov_b32 v106, 0
    v_mov_b32 v107, 0
    v_readlane_b32 s77, v29, 0
    v_readlane_b32 s78, v29, 32
    v_readlane_b32 s79, v29, 1
    v_readlane_b32 s80, v29, 33
    v_readlane_b32 s81, v29, 2
    v_readlane_b32 s82, v29, 34
    v_readlane_b32 s83, v29, 3
    v_readlane_b32 s84, v29, 35
    v_readlane_b32 s85, v29, 4
    v_readlane_b32 s86, v29, 36
    v_readlane_b32 s87, v29, 5
    v_readlane_b32 s88, v29, 37
    v_readlane_b32 s89, v29, 6
    v_readlane_b32 s90, v29, 38
    v_readlane_b32 s91, v29, 7
    v_readlane_b32 s92, v29, 39
    s_waitcnt vmcnt(49)
    v_lshlrev_b32 v38, 16, v64
    v_and_b32 v39, s47, v64
    v_fmac_f32 v104, s77, v38
    v_fmac_f32 v105, s77, v39
    v_fmac_f32 v106, s78, v38
    v_fmac_f32 v107, s78, v39
    s_waitcnt vmcnt(48)
    v_lshlrev_b32 v38, 16, v65
    v_and_b32 v39, s47, v65
    v_fmac_f32 v104, s79, v38
    v_fmac_f32 v105, s79, v39
    v_fmac_f32 v106, s80, v38
    v_fmac_f32 v107, s80, v39
    s_waitcnt vmcnt(47)
    v_lshlrev_b32 v38, 16, v66
    v_and_b32 v39, s47, v66
    v_fmac_f32 v104, s81, v38
    v_fmac_f32 v105, s81, v39
    v_fmac_f32 v106, s82, v38
    v_fmac_f32 v107, s82, v39
    s_waitcnt vmcnt(46)
    v_lshlrev_b32 v38, 16, v67
    v_and_b32 v39, s47, v67
    v_fmac_f32 v104, s83, v38
    v_fmac_f32 v105, s83, v39
    v_fmac_f32 v106, s84, v38
    v_fmac_f32 v107, s84, v39
    s_waitcnt vmcnt(45)
    v_lshlrev_b32 v38, 16, v68
    v_and_b32 v39, s47, v68
    v_fmac_f32 v104, s85, v38
    v_fmac_f32 v105, s85, v39
    v_fmac_f32 v106, s86, v38
    v_fmac_f32 v107, s86, v39
    s_waitcnt vmcnt(44)
    v_lshlrev_b32 v38, 16, v69
    v_and_b32 v39, s47, v69
    v_fmac_f32 v104, s87, v38
    v_fmac_f32 v105, s87, v39
    v_fmac_f32 v106, s88, v38
    v_fmac_f32 v107, s88, v39
    s_waitcnt vmcnt(43)
    v_lshlrev_b32 v38, 16, v70
    v_and_b32 v39, s47, v70
    v_fmac_f32 v104, s89, v38
    v_fmac_f32 v105, s89, v39
    v_fmac_f32 v106, s90, v38
    v_fmac_f32 v107, s90, v39
    s_waitcnt vmcnt(42)
    v_lshlrev_b32 v38, 16, v71
    v_and_b32 v39, s47, v71
    v_fmac_f32 v104, s91, v38
    v_fmac_f32 v105, s91, v39
    v_fmac_f32 v106, s92, v38
    v_fmac_f32 v107, s92, v39
    v_readlane_b32 s77, v29, 8
    v_readlane_b32 s78, v29, 40
    v_readlane_b32 s79, v29, 9
    v_readlane_b32 s80, v29, 41
    v_readlane_b32 s81, v29, 10
    v_readlane_b32 s82, v29, 42
    v_readlane_b32 s83, v29, 11
    v_readlane_b32 s84, v29, 43
    v_readlane_b32 s85, v29, 12
    v_readlane_b32 s86, v29, 44
    v_readlane_b32 s87, v29, 13
    v_readlane_b32 s88, v29, 45
    v_readlane_b32 s89, v29, 14
    v_readlane_b32 s90, v29, 46
    v_readlane_b32 s91, v29, 15
    v_readlane_b32 s92, v29, 47
    s_waitcnt vmcnt(41)
    v_lshlrev_b32 v38, 16, v72
    v_and_b32 v39, s47, v72
    v_fmac_f32 v104, s77, v38
    v_fmac_f32 v105, s77, v39
    v_fmac_f32 v106, s78, v38
    v_fmac_f32 v107, s78, v39
    s_waitcnt vmcnt(40)
    v_lshlrev_b32 v38, 16, v73
    v_and_b32 v39, s47, v73
    v_fmac_f32 v104, s79, v38
    v_fmac_f32 v105, s79, v39
    v_fmac_f32 v106, s80, v38
    v_fmac_f32 v107, s80, v39
    s_waitcnt vmcnt(39)
    v_lshlrev_b32 v38, 16, v74
    v_and_b32 v39, s47, v74
    v_fmac_f32 v104, s81, v38
    v_fmac_f32 v105, s81, v39
    v_fmac_f32 v106, s82, v38
    v_fmac_f32 v107, s82, v39
    s_waitcnt vmcnt(38)
    v_lshlrev_b32 v38, 16, v75
    v_and_b32 v39, s47, v75
    v_fmac_f32 v104, s83, v38
    v_fmac_f32 v105, s83, v39
    v_fmac_f32 v106, s84, v38
    v_fmac_f32 v107, s84, v39
    s_waitcnt vmcnt(37)
    v_lshlrev_b32 v38, 16, v76
    v_and_b32 v39, s47, v76
    v_fmac_f32 v104, s85, v38
    v_fmac_f32 v105, s85, v39
    v_fmac_f32 v106, s86, v38
    v_fmac_f32 v107, s86, v39
    s_waitcnt vmcnt(36)
    v_lshlrev_b32 v38, 16, v77
    v_and_b32 v39, s47, v77
    v_fmac_f32 v104, s87, v38
    v_fmac_f32 v105, s87, v39
    v_fmac_f32 v106, s88, v38
    v_fmac_f32 v107, s88, v39
    s_waitcnt vmcnt(35)
    v_lshlrev_b32 v38, 16, v78
    v_and_b32 v39, s47, v78
    v_fmac_f32 v104, s89, v38
    v_fmac_f32 v105, s89, v39
    v_fmac_f32 v106, s90, v38
    v_fmac_f32 v107, s90, v39
    s_waitcnt vmcnt(34)
    v_lshlrev_b32 v38, 16, v79
    v_and_b32 v39, s47, v79
    v_fmac_f32 v104, s91, v38
    v_fmac_f32 v105, s91, v39
    v_fmac_f32 v106, s92, v38
    v_fmac_f32 v107, s92, v39
    v_readlane_b32 s77, v29, 16
    v_readlane_b32 s78, v29, 48
    v_readlane_b32 s79, v29, 17
    v_readlane_b32 s80, v29, 49
    v_readlane_b32 s81, v29, 18
    v_readlane_b32 s82, v29, 50
    v_readlane_b32 s83, v29, 19
    v_readlane_b32 s84, v29, 51
    v_readlane_b32 s85, v29, 20
    v_readlane_b32 s86, v29, 52
    v_readlane_b32 s87, v29, 21
    v_readlane_b32 s88, v29, 53
    v_readlane_b32 s89, v29, 22
    v_readlane_b32 s90, v29, 54
    v_readlane_b32 s91, v29, 23
    v_readlane_b32 s92, v29, 55
    s_waitcnt vmcnt(33)
    v_lshlrev_b32 v38, 16, v80
    v_and_b32 v39, s47, v80
    v_fmac_f32 v104, s77, v38
    v_fmac_f32 v105, s77, v39
    v_fmac_f32 v106, s78, v38
    v_fmac_f32 v107, s78, v39
    s_waitcnt vmcnt(32)
    v_lshlrev_b32 v38, 16, v81
    v_and_b32 v39, s47, v81
    v_fmac_f32 v104, s79, v38
    v_fmac_f32 v105, s79, v39
    v_fmac_f32 v106, s80, v38
    v_fmac_f32 v107, s80, v39
    s_waitcnt vmcnt(31)
    v_lshlrev_b32 v38, 16, v82
    v_and_b32 v39, s47, v82
    v_fmac_f32 v104, s81, v38
    v_fmac_f32 v105, s81, v39
    v_fmac_f32 v106, s82, v38
    v_fmac_f32 v107, s82, v39
    s_waitcnt vmcnt(30)
    v_lshlrev_b32 v38, 16, v83
    v_and_b32 v39, s47, v83
    v_fmac_f32 v104, s83, v38
    v_fmac_f32 v105, s83, v39
    v_fmac_f32 v106, s84, v38
    v_fmac_f32 v107, s84, v39
    s_waitcnt vmcnt(29)
    v_lshlrev_b32 v38, 16, v84
    v_and_b32 v39, s47, v84
    v_fmac_f32 v104, s85, v38
    v_fmac_f32 v105, s85, v39
    v_fmac_f32 v106, s86, v38
    v_fmac_f32 v107, s86, v39
    s_waitcnt vmcnt(28)
    v_lshlrev_b32 v38, 16, v85
    v_and_b32 v39, s47, v85
    v_fmac_f32 v104, s87, v38
    v_fmac_f32 v105, s87, v39
    v_fmac_f32 v106, s88, v38
    v_fmac_f32 v107, s88, v39
    s_waitcnt vmcnt(27)
    v_lshlrev_b32 v38, 16, v86
    v_and_b32 v39, s47, v86
    v_fmac_f32 v104, s89, v38
    v_fmac_f32 v105, s89, v39
    v_fmac_f32 v106, s90, v38
    v_fmac_f32 v107, s90, v39
    s_waitcnt vmcnt(26)
    v_lshlrev_b32 v38, 16, v87
    v_and_b32 v39, s47, v87
    v_fmac_f32 v104, s91, v38
    v_fmac_f32 v105, s91, v39
    v_fmac_f32 v106, s92, v38
    v_fmac_f32 v107, s92, v39
    v_readlane_b32 s77, v29, 24
    v_readlane_b32 s78, v29, 56
    v_readlane_b32 s79, v29, 25
    v_readlane_b32 s80, v29, 57
    v_readlane_b32 s81, v29, 26
    v_readlane_b32 s82, v29, 58
    v_readlane_b32 s83, v29, 27
    v_readlane_b32 s84, v29, 59
    v_readlane_b32 s85, v29, 28
    v_readlane_b32 s86, v29, 60
    v_readlane_b32 s87, v29, 29
    v_readlane_b32 s88, v29, 61
    v_readlane_b32 s89, v29, 30
    v_readlane_b32 s90, v29, 62
    v_readlane_b32 s91, v29, 31
    v_readlane_b32 s92, v29, 63
    s_waitcnt vmcnt(25)
    v_lshlrev_b32 v38, 16, v88
    v_and_b32 v39, s47, v88
    v_fmac_f32 v104, s77, v38
    v_fmac_f32 v105, s77, v39
    v_fmac_f32 v106, s78, v38
    v_fmac_f32 v107, s78, v39
    s_waitcnt vmcnt(24)
    v_lshlrev_b32 v38, 16, v89
    v_and_b32 v39, s47, v89
    v_fmac_f32 v104, s79, v38
    v_fmac_f32 v105, s79, v39
    v_fmac_f32 v106, s80, v38
    v_fmac_f32 v107, s80, v39
    s_waitcnt vmcnt(23)
    v_lshlrev_b32 v38, 16, v90
    v_and_b32 v39, s47, v90
    v_fmac_f32 v104, s81, v38
    v_fmac_f32 v105, s81, v39
    v_fmac_f32 v106, s82, v38
    v_fmac_f32 v107, s82, v39
    s_waitcnt vmcnt(22)
    v_lshlrev_b32 v38, 16, v91
    v_and_b32 v39, s47, v91
    v_fmac_f32 v104, s83, v38
    v_fmac_f32 v105, s83, v39
    v_fmac_f32 v106, s84, v38
    v_fmac_f32 v107, s84, v39
    s_waitcnt vmcnt(21)
    v_lshlrev_b32 v38, 16, v92
    v_and_b32 v39, s47, v92
    v_fmac_f32 v104, s85, v38
    v_fmac_f32 v105, s85, v39
    v_fmac_f32 v106, s86, v38
    v_fmac_f32 v107, s86, v39
    s_waitcnt vmcnt(20)
    v_lshlrev_b32 v38, 16, v93
    v_and_b32 v39, s47, v93
    v_fmac_f32 v104, s87, v38
    v_fmac_f32 v105, s87, v39
    v_fmac_f32 v106, s88, v38
    v_fmac_f32 v107, s88, v39
    s_waitcnt vmcnt(19)
    v_lshlrev_b32 v38, 16, v94
    v_and_b32 v39, s47, v94
    v_fmac_f32 v104, s89, v38
    v_fmac_f32 v105, s89, v39
    v_fmac_f32 v106, s90, v38
    v_fmac_f32 v107, s90, v39
    s_waitcnt vmcnt(18)
    v_lshlrev_b32 v38, 16, v95
    v_and_b32 v39, s47, v95
    v_fmac_f32 v104, s91, v38
    v_fmac_f32 v105, s91, v39
    v_fmac_f32 v106, s92, v38
    v_fmac_f32 v107, s92, v39
    s_lshl_b32 s50, s2, 7
    s_add_u32 s50, s50, 622592
    s_add_u32 s51, s50, 18432
    v_lshrrev_b32 v38, 4, v1
    v_mul_u32_u24 v38, 4608, v38
    v_and_b32 v39, 15, v1
    v_lshl_add_u32 v38, v39, 3, v38
    buffer_store_dwordx2 v[104:105], v38, s[32:35], s50 offen sc1
    buffer_store_dwordx2 v[106:107], v38, s[32:35], s51 offen sc1
    v_lshlrev_b32 v30, 4, v0
    v_bfe_u32 v31, v0, 4, 3
    v_lshrrev_b32 v32, 1, v31
    v_mul_u32_u24 v32, 9248, v32
    v_and_b32 v31, 1, v31
    v_mul_u32_u24 v31, 8976, v31
    v_and_b32 v33, 15, v0
    v_lshlrev_b32 v33, 4, v33
    v_add3_u32 v31, v31, v32, v33
    v_mov_b32 v32, 0
    v_mov_b32 v33, 0
    v_mov_b32 v34, 0
    v_mov_b32 v35, 0
    ds_write_b128 v30, v[32:35] offset:0
    ds_write_b128 v30, v[32:35] offset:43200
    ds_write_b128 v30, v[32:35] offset:4096
    ds_write_b128 v30, v[32:35] offset:47296
    ds_write_b128 v30, v[32:35] offset:8192
    ds_write_b128 v30, v[32:35] offset:51392
    ds_write_b128 v31, v[32:35] offset:9248
    v_and_b32 v30, 15, v1
    v_lshrrev_b32 v31, 4, v1
    v_and_b32 v32, 31, v1
    v_mul_u32_u24 v32, 272, v32
    v_lshrrev_b32 v33, 5, v1
    v_lshl_add_u32 v3, v33, 4, v32
    s_mul_i32 s50, s40, 73728
    v_add_u32 v4, s50, v2
    v_mul_u32_u24 v34, 192, v30
    v_lshl_add_u32 v35, v31, 4, v34
    s_mul_i32 s50, s40, 12288
    s_add_u32 s50, s50, 69840
    v_add_u32 v6, s50, v35
    s_lshr_b32 s51, s40, 1
    s_and_b32 s52, s40, 1
    s_mul_i32 s50, s51, 61440
    s_lshl_b32 s53, s52, 5
    s_add_u32 s50, s50, s53
    s_add_u32 s50, s50, 57552
    v_lshl_add_u32 v35, v31, 3, v34
    v_add_u32 v7, s50, v35
    v_lshlrev_b32 v36, 2, v30
    v_mul_u32_u24 v37, 2176, v31
    v_add_u32 v37, v37, v36
    s_mul_i32 s50, s40, 9248
    s_add_u32 s50, s50, 9520
    v_add_u32 v9, s50, v37
    v_mul_u32_u24 v37, 1088, v31
    v_add_u32 v37, v37, v36
    s_mul_i32 s50, s51, 46240
    s_mul_i32 s53, s52, 4352
    s_add_u32 s50, s50, s53
    s_add_u32 s50, s50, 272
    s_cmp_eq_u32 s51, 0
    s_cselect_b32 s54, 0, 31
    s_cmp_lg_u32 s42, s54
    s_cselect_b32 s55, -1, 0
    v_add_u32 v37, s50, v37
    v_add_u32 v38, 55488, v36
    v_mov_b32 v39, s55
    v_cmp_ne_u32 vcc, 0, v39
    s_nop 1
    v_cndmask_b32 v10, v38, v37, vcc
    s_lshl_b32 s50, s40, 2
    v_add_u32 v37, s50, v31
    v_lshrrev_b32 v39, 1, v37
    v_and_b32 v31, 1, v37
    v_min_u32 v35, 5, v39
    v_mul_u32_u24 v35, 12288, v35
    v_add_u32 v35, v35, v34
    v_mul_u32_u24 v33, 66, v31
    v_add_u32 v35, v35, v33
    v_add_u32 v8, 57550, v35
    v_mul_u32_u24 v35, 9248, v39
    v_mul_u32_u24 v33, 8976, v31
    v_add3_u32 v35, v35, v33, v36
    v_cmp_gt_u32 vcc, 12, v37
    s_nop 0
    s_mov_b64 s[56:57], vcc
    s_cmp_eq_u32 s42, 0
    s_cselect_b32 s54, 0, 99
    v_cmp_ne_u32 vcc, s54, v39
    s_nop 0
    s_and_b64 s[56:57], s[56:57], vcc
    s_cmp_eq_u32 s42, 31
    s_cselect_b32 s54, 5, 99
    v_cmp_ne_u32 vcc, s54, v39
    s_nop 0
    s_and_b64 s[56:57], s[56:57], vcc
    s_cmp_eq_u32 s43, 0
    s_cselect_b32 s54, 0, 99
    v_cmp_ne_u32 vcc, s54, v31
    s_nop 0
    s_and_b64 s[56:57], s[56:57], vcc
    s_cmp_eq_u32 s43, 3
    s_cselect_b32 s54, 1, 99
    v_cmp_ne_u32 vcc, s54, v31
    s_nop 0
    s_and_b64 vcc, s[56:57], vcc
    v_cndmask_b32 v11, v38, v35, vcc
    s_lshl_b32 s50, s41, 5
    s_add_u32 s50, s50, s42
    s_lshl_b32 s50, s50, 2
    s_add_u32 s46, s50, s43
    s_mov_b32 s47, 0xffff0000
    s_mov_b32 s48, 0xbf317218
    s_mov_b32 s49, 0xbf317218
    s_mov_b32 s36, s22
    s_mov_b32 s37, s23
    s_mov_b32 s38, 0x800000
    s_mov_b32 s39, 0x20000
    s_lshl_b32 s50, s46, 15
    s_lshl_b32 s51, s40, 11
    s_add_u32 s50, s50, s51
    s_add_u32 s71, s50, 1048576
    s_mov_b32 s72, s71
    s_add_u32 s73, s71, 8192
    s_add_u32 s74, s71, 16384
    s_add_u32 s75, s71, 24576
    s_sub_u32 s52, s71, 106496
    s_cmp_eq_u32 s42, 0
    s_cselect_b32 s76, s71, s52
    s_add_u32 s53, s71, 131072
    s_cmp_eq_u32 s42, 31
    s_cselect_b32 s77, s71, s53
    s_add_u32 s78, s51, 1048576
    s_lshl_b32 s50, s41, 22
    s_lshl_b32 s51, s40, 20
    s_add_u32 s50, s50, s51
    s_lshl_b32 s51, s44, 8
    s_add_u32 s50, s50, s51
    s_add_u32 s79, s50, s45
    s_lshl_b32 s50, s41, 2
    s_add_u32 s50, s50, s40
    s_mul_i32 s51, s50, 4608
    s_add_u32 s85, s51, 622592
    s_add_u32 s86, s85, 4096
    s_lshl_b32 s51, s50, 11
    s_add_u32 s51, s51, 589824
    s_lshl_b32 s52, s42, 2
    s_add_u32 s52, s52, s43
    s_lshl_b32 s52, s52, 3
    s_add_u32 s80, s51, s52
    s_and_b32 s52, s2, 1
    s_lshl_b32 s52, s52, 10
    s_add_u32 s81, s51, s52
    s_mov_b64 s[82:83], 0x3f
    s_lshl_b32 s52, s42, 1
    s_sub_u32 s52, s52, 2
    s_lshl_b64 s[82:83], s[82:83], s52
    s_cmp_eq_u32 s42, 0
    s_cselect_b64 s[82:83], 15, s[82:83]
    v_and_b32 v56, 31, v1
    v_lshrrev_b32 v57, 5, v1
    s_lshl_b32 s50, s40, 4
    v_lshl_add_u32 v58, v57, 3, s50
    v_mul_u32_u24 v59, 272, v56
    v_add_u32 v59, v59, v58
    v_add_u32 v12, 272, v59
    v_add_u32 v60, 55488, v58
    s_cmp_lg_u32 s42, 0
    s_cselect_b32 s54, -1, 0
    v_mov_b32 v61, s54
    v_cmp_ne_u32 vcc, 0, v61
    s_nop 1
    v_cndmask_b32 v13, v60, v12, vcc
    v_add_u32 v62, 46240, v12
    s_cmp_lg_u32 s42, 31
    s_cselect_b32 s54, -1, 0
    v_mov_b32 v61, s54
    v_cmp_ne_u32 vcc, 0, v61
    s_nop 1
    v_cndmask_b32 v14, v60, v62, vcc
    v_lshrrev_b32 v61, 1, v56
    v_and_b32 v62, 1, v56
    v_mul_u32_u24 v63, 9248, v61
    v_mul_u32_u24 v20, 8976, v62
    v_add3_u32 v63, v63, v20, v58
    v_cmp_gt_u32 vcc, 12, v56
    s_nop 0
    s_mov_b64 s[56:57], vcc
    s_cmp_eq_u32 s42, 0
    s_cselect_b32 s54, 0, 99
    v_cmp_ne_u32 vcc, s54, v61
    s_nop 0
    s_and_b64 s[56:57], s[56:57], vcc
    s_cmp_eq_u32 s42, 31
    s_cselect_b32 s54, 5, 99
    v_cmp_ne_u32 vcc, s54, v61
    s_nop 0
    s_and_b64 s[56:57], s[56:57], vcc
    s_cmp_eq_u32 s43, 0
    s_cselect_b32 s54, 0, 99
    v_cmp_ne_u32 vcc, s54, v62
    s_nop 0
    s_and_b64 s[56:57], s[56:57], vcc
    s_cmp_eq_u32 s43, 3
    s_cselect_b32 s54, 1, 99
    v_cmp_ne_u32 vcc, s54, v62
    s_nop 0
    s_and_b64 s[56:57], s[56:57], vcc
    s_mov_b64 vcc, s[56:57]
    v_cndmask_b32 v15, v60, v63, vcc
    v_cmp_eq_u32 vcc, 0, v61
    s_nop 1
    v_cndmask_b32 v63, 0, -4, vcc
    v_add_u32 v20, -1, v61
    v_cndmask_b32 v20, v20, 3, vcc
    v_cmp_eq_u32 vcc, 5, v61
    s_nop 1
    v_cndmask_b32 v63, v63, 4, vcc
    v_cndmask_b32 v20, v20, 0, vcc
    v_lshl_add_u32 v63, v62, 1, v63
    v_add_u32 v63, -1, v63
    v_add_u32 v63, s46, v63
    v_lshlrev_b32 v63, 15, v63
    v_lshl_add_u32 v63, v20, 13, v63
    v_lshlrev_b32 v20, 5, v57
    v_xor_b32 v21, 1, v62
    v_mul_u32_u24 v21, 31, v21
    v_add_u32 v20, v20, v21
    v_lshl_add_u32 v63, v20, 4, v63
    s_lshl_b32 s54, s46, 15
    v_mov_b32 v20, s54
    s_mov_b64 vcc, s[56:57]
    v_cndmask_b32 v16, v20, v63, vcc
    v_lshlrev_b32 v59, 15, v56
    v_lshl_add_u32 v17, v57, 4, v59
    v_and_b32 v59, 15, v1
    v_lshlrev_b32 v59, 15, v59
    v_lshl_add_u32 v17, v57, 4, v59
    v_bfe_u32 v59, v1, 4, 1
    v_lshl_add_u32 v17, v59, 5, v17
    s_mul_i32 s50, s40, 3072
    s_add_u32 s50, s50, 57552
    v_mul_u32_u24 v59, 96, v56
    v_lshl_add_u32 v59, v57, 3, v59
    v_add_u32 v18, s50, v59
    v_cmp_eq_u32 vcc, 0, v56
    v_cmp_eq_u32 s[56:57], 31, v56
    s_nop 0
    s_or_b64 vcc, vcc, s[56:57]
    v_mov_b32 v59, 1073741824
    v_cndmask_b32 v5, v59, v2, vcc
    v_mov_b32 v56, 0
    v_mov_b32 v57, 0
    v_mov_b32 v58, 0
    v_mov_b32 v59, 0
    s_waitcnt vmcnt(2)
    s_add_u32 s50, s63, 1048576
    s_mov_b32 m0, 72896
    s_nop 0
    buffer_load_dwordx4 v164, s[28:31], s50 offen lds
    s_mov_b32 m0, 73920
    s_nop 0
    buffer_load_dwordx4 v165, s[28:31], s50 offen lds
    s_mov_b32 m0, 74944
    s_nop 0
    buffer_load_dwordx4 v166, s[28:31], s50 offen lds
    s_add_u32 s50, s64, 1048576
    s_mov_b32 m0, 85184
    s_nop 0
    buffer_load_dwordx4 v164, s[28:31], s50 offen lds
    s_mov_b32 m0, 86208
    s_nop 0
    buffer_load_dwordx4 v165, s[28:31], s50 offen lds
    s_mov_b32 m0, 87232
    s_nop 0
    buffer_load_dwordx4 v166, s[28:31], s50 offen lds
    s_add_u32 s50, s65, 1048576
    s_mov_b32 m0, 97472
    s_nop 0
    buffer_load_dwordx4 v164, s[28:31], s50 offen lds
    s_mov_b32 m0, 98496
    s_nop 0
    buffer_load_dwordx4 v165, s[28:31], s50 offen lds
    s_mov_b32 m0, 99520
    s_nop 0
    buffer_load_dwordx4 v166, s[28:31], s50 offen lds
    s_add_u32 s50, s66, 1048576
    s_mov_b32 m0, 109760
    s_nop 0
    buffer_load_dwordx4 v164, s[28:31], s50 offen lds
    s_mov_b32 m0, 110784
    s_nop 0
    buffer_load_dwordx4 v165, s[28:31], s50 offen lds
    s_mov_b32 m0, 111808
    s_nop 0
    buffer_load_dwordx4 v166, s[28:31], s50 offen lds
    s_add_u32 s50, s62, 1048576
    s_mov_b32 m0, 60608
    s_nop 0
    buffer_load_dwordx4 v164, s[28:31], s50 offen lds
    s_mov_b32 m0, 61632
    s_nop 0
    buffer_load_dwordx4 v165, s[28:31], s50 offen lds
    s_mov_b32 m0, 62656
    s_nop 0
    buffer_load_dwordx4 v166, s[28:31], s50 offen lds
    s_add_u32 s50, s67, 1048576
    s_mov_b32 m0, 122048
    s_nop 0
    buffer_load_dwordx4 v164, s[28:31], s50 offen lds
    s_mov_b32 m0, 123072
    s_nop 0
    buffer_load_dwordx4 v165, s[28:31], s50 offen lds
    s_mov_b32 m0, 124096
    s_nop 0
    buffer_load_dwordx4 v166, s[28:31], s50 offen lds
    s_lshl_b32 s52, s41, 22
    s_lshl_b32 s53, s44, 8
    s_add_u32 s52, s52, s53
    s_add_u32 s52, s52, 3145472
    s_mul_i32 s50, s40, 5
    s_cmp_eq_u32 s42, 0
    s_cselect_b32 s54, 1, 0
    s_cmp_eq_u32 s42, 31
    s_cselect_b32 s55, 4, 5
    v_add_u32 v30, s50, v1
    v_mov_b32 v33, s55
    v_cmp_le_u32 vcc, 18, v30
    s_nop 1
    v_cndmask_b32 v31, 0, 3, vcc
    v_sub_u32 v30, v30, v31
    v_mul_u32_u24 v31, 43, v30
    v_lshrrev_b32 v31, 7, v31
    v_mul_u32_u24 v32, 3, v31
    v_sub_u32 v32, v30, v32
    v_lshlrev_b32 v32, 10, v32
    v_mul_u32_u24 v30, 12288, v31
    v_med3_u32 v31, v31, s54, v33
    v_add_u32 v32, 63680, v32
    v_lshl_add_u32 v31, v31, 8, s52
    v_add_u32 v32, v32, v30
    v_readlane_b32 s62, v31, 0
    v_readlane_b32 s67, v32, 0
    v_readlane_b32 s63, v31, 1
    v_readlane_b32 s68, v32, 1
    v_readlane_b32 s64, v31, 2
    v_readlane_b32 s71, v32, 2
    v_readlane_b32 s65, v31, 3
    v_readlane_b32 s84, v32, 3
    v_readlane_b32 s66, v31, 4
    v_readlane_b32 s96, v32, 4
    s_waitcnt lgkmcnt(0)
    s_barrier
    v_mov_b32 v31, 131264
    ds_read_b32 v30, v31 offset:12
    v_mov_b32 v22, 0
    v_mov_b32 v23, 0
    ds_read_b128 v[44:47], v6 offset:0
    ds_read_b128 v[48:51], v6 offset:96
    ds_read_b64 v[52:53], v7 offset:0
    ds_read_b64 v[54:55], v7 offset:96
    ds_read_u16_d16_hi v22, v8 offset:0
    ds_read_u16_d16_hi v23, v8 offset:96
    s_waitcnt lgkmcnt(5)
    v_lshlrev_b32 v136, 16, v44
    s_waitcnt lgkmcnt(4)
    v_lshlrev_b32 v137, 16, v48
    v_and_b32 v138, s47, v44
    v_and_b32 v139, s47, v48
    v_lshlrev_b32 v140, 16, v45
    v_lshlrev_b32 v141, 16, v49
    v_and_b32 v142, s47, v45
    v_and_b32 v143, s47, v49
    v_lshlrev_b32 v144, 16, v46
    v_lshlrev_b32 v145, 16, v50
    v_and_b32 v146, s47, v46
    v_and_b32 v147, s47, v50
    v_lshlrev_b32 v148, 16, v47
    v_lshlrev_b32 v149, 16, v51
    v_and_b32 v150, s47, v47
    v_and_b32 v151, s47, v51
    s_waitcnt lgkmcnt(3)
    v_lshlrev_b32 v152, 16, v52
    s_waitcnt lgkmcnt(2)
    v_lshlrev_b32 v153, 16, v54
    v_and_b32 v154, s47, v52
    v_and_b32 v155, s47, v54
    v_lshlrev_b32 v156, 16, v53
    v_lshlrev_b32 v157, 16, v55
    v_and_b32 v158, s47, v53
    v_and_b32 v159, s47, v55
    s_waitcnt lgkmcnt(1)
    v_mov_b32 v160, v22
    s_waitcnt lgkmcnt(0)
    v_mov_b32 v161, v23
    s_lshl_b32 s50, s2, 2
    s_add_u32 s50, s50, 610304
    s_waitcnt vmcnt(18)
    s_mov_b64 exec, 1
    buffer_store_dword v30, off, s[32:35], s50 sc1
    s_mov_b64 exec, -1
    v_lshlrev_b32 v24, 16, v168
    v_and_b32 v25, s47, v168
    v_lshlrev_b32 v26, 16, v172
    v_and_b32 v27, s47, v172
    v_lshlrev_b32 v28, 16, v169
    v_and_b32 v29, s47, v169
    v_lshlrev_b32 v30, 16, v173
    v_and_b32 v31, s47, v173
    v_lshlrev_b32 v32, 16, v170
    v_and_b32 v33, s47, v170
    v_lshlrev_b32 v34, 16, v174
    v_and_b32 v35, s47, v174
    v_lshlrev_b32 v36, 16, v171
    v_and_b32 v37, s47, v171
    v_lshlrev_b32 v38, 16, v175
    v_and_b32 v39, s47, v175
    s_mov_b32 s50, 0xbfb8aa3b
    v_mul_f32 v24, s50, v24
    v_mul_f32 v25, s50, v25
    v_mul_f32 v26, s50, v26
    v_mul_f32 v27, s50, v27
    v_mul_f32 v28, s50, v28
    v_mul_f32 v29, s50, v29
    v_mul_f32 v30, s50, v30
    v_mul_f32 v31, s50, v31
    v_mul_f32 v32, s50, v32
    v_mul_f32 v33, s50, v33
    v_mul_f32 v34, s50, v34
    v_mul_f32 v35, s50, v35
    v_mul_f32 v36, s50, v36
    v_mul_f32 v37, s50, v37
    v_mul_f32 v38, s50, v38
    v_mul_f32 v39, s50, v39
    s_lshl_b32 s50, s41, 22
    s_lshl_b32 s51, s44, 8
    s_add_u32 s50, s50, s51
    s_add_u32 s52, s50, 768
    s_add_u32 s53, s50, 1024
    s_add_u32 s54, s50, 768
    s_cmp_eq_u32 s42, 31
    s_cselect_b32 s53, s54, s53
    s_add_u32 s55, s52, 2097152
    s_mov_b32 m0, 112832
    s_nop 0
    buffer_load_dwordx4 v164, s[28:31], s55 offen lds
    s_mov_b32 m0, 113856
    s_nop 0
    buffer_load_dwordx4 v165, s[28:31], s55 offen lds
    s_mov_b32 m0, 114880
    s_nop 0
    buffer_load_dwordx4 v166, s[28:31], s55 offen lds
    s_add_u32 s55, s53, 2097152
    s_mov_b32 m0, 125120
    s_nop 0
    buffer_load_dwordx4 v164, s[28:31], s55 offen lds
    s_mov_b32 m0, 126144
    s_nop 0
    buffer_load_dwordx4 v165, s[28:31], s55 offen lds
    s_mov_b32 m0, 127168
    s_nop 0
    buffer_load_dwordx4 v166, s[28:31], s55 offen lds
    s_waitcnt lgkmcnt(0)
    s_barrier
    s_branch L_common
.p2align 12
L_common:
    v_and_b32 v20, 7, v1
    v_lshlrev_b32 v20, 2, v20
    v_add_u32 v20, 131296, v20
    ds_read_b32 v21, v20
    v_mov_b32 v61, 131264
    ds_read_b32 v60, v61 offset:12
    s_mov_b32 s69, 0
    buffer_load_dwordx4 a[0:3], v4, s[32:35], s69 offen offset:0 sc1
    buffer_load_dwordx4 a[4:7], v4, s[32:35], s69 offen offset:1024 sc1
    buffer_load_dwordx4 a[8:11], v4, s[32:35], s69 offen offset:2048 sc1
    s_waitcnt lgkmcnt(0)
    v_readfirstlane_b32 s60, v60
    v_readlane_b32 s88, v21, 0
    v_readlane_b32 s92, v21, 1
    v_readlane_b32 s89, v21, 2
    v_readlane_b32 s93, v21, 3
    v_readlane_b32 s90, v21, 4
    v_readlane_b32 s94, v21, 5
    v_readlane_b32 s91, v21, 6
    v_readlane_b32 s95, v21, 7
    v_mul_f32 v40, s92, v24
    v_mul_f32 v41, s92, v25
    v_fma_f32 v42, -v40, s88, v26
    v_fma_f32 v43, -v41, s88, v27
    v_fma_f32 v136, v136, v40, v42
    v_fma_f32 v137, v137, v41, v43
    v_fma_f32 v138, v138, v40, v42
    v_fma_f32 v139, v139, v41, v43
    v_fma_f32 v140, v140, v40, v42
    v_fma_f32 v141, v141, v41, v43
    v_fma_f32 v142, v142, v40, v42
    v_fma_f32 v143, v143, v41, v43
    v_exp_f32 v216, v136
    v_exp_f32 v217, v137
    v_exp_f32 v218, v138
    v_exp_f32 v219, v139
    v_exp_f32 v220, v140
    v_exp_f32 v221, v141
    v_exp_f32 v222, v142
    v_exp_f32 v223, v143
    v_add_f32 v216, 1.0, v216
    v_add_f32 v217, 1.0, v217
    v_add_f32 v218, 1.0, v218
    v_add_f32 v219, 1.0, v219
    v_add_f32 v220, 1.0, v220
    v_add_f32 v221, 1.0, v221
    v_add_f32 v222, 1.0, v222
    v_add_f32 v223, 1.0, v223
    v_rcp_f32 v216, v216
    v_rcp_f32 v217, v217
    v_rcp_f32 v218, v218
    v_rcp_f32 v219, v219
    v_rcp_f32 v220, v220
    v_rcp_f32 v221, v221
    v_rcp_f32 v222, v222
    v_rcp_f32 v223, v223
    v_mul_f32 v136, v136, v216
    v_mul_f32 v137, v137, v217
    v_mul_f32 v138, v138, v218
    v_mul_f32 v139, v139, v219
    buffer_load_dwordx4 a[12:15], v4, s[32:35], s69 offen offset:3072 sc1
    v_mul_f32 v140, v140, v220
    v_mul_f32 v141, v141, v221
    v_mul_f32 v142, v142, v222
    v_mul_f32 v143, v143, v223
    v_cvt_pk_bf16_f32 v216, v136, v137
    ds_write_b32 v9, v216 offset:0
    v_cvt_pk_bf16_f32 v218, v138, v139
    ds_write_b32 v9, v218 offset:272
    v_cvt_pk_bf16_f32 v220, v140, v141
    ds_write_b32 v9, v220 offset:544
    v_cvt_pk_bf16_f32 v222, v142, v143
    ds_write_b32 v9, v222 offset:816
    v_fma_f32 v144, v144, v40, v42
    v_fma_f32 v145, v145, v41, v43
    v_fma_f32 v146, v146, v40, v42
    v_fma_f32 v147, v147, v41, v43
    v_fma_f32 v148, v148, v40, v42
    v_fma_f32 v149, v149, v41, v43
    v_fma_f32 v150, v150, v40, v42
    v_fma_f32 v151, v151, v41, v43
    v_exp_f32 v216, v144
    v_exp_f32 v217, v145
    v_exp_f32 v218, v146
    v_exp_f32 v219, v147
    v_exp_f32 v220, v148
    v_exp_f32 v221, v149
    v_exp_f32 v222, v150
    v_exp_f32 v223, v151
    v_add_f32 v216, 1.0, v216
    v_add_f32 v217, 1.0, v217
    v_add_f32 v218, 1.0, v218
    v_add_f32 v219, 1.0, v219
    v_add_f32 v220, 1.0, v220
    v_add_f32 v221, 1.0, v221
    v_add_f32 v222, 1.0, v222
    v_add_f32 v223, 1.0, v223
    v_rcp_f32 v216, v216
    v_rcp_f32 v217, v217
    v_rcp_f32 v218, v218
    v_rcp_f32 v219, v219
    s_mov_b32 s69, 4096
    buffer_load_dwordx4 a[16:19], v4, s[32:35], s69 offen offset:0 sc1
    v_rcp_f32 v220, v220
    v_rcp_f32 v221, v221
    v_rcp_f32 v222, v222
    v_rcp_f32 v223, v223
    v_mul_f32 v144, v144, v216
    v_mul_f32 v145, v145, v217
    v_mul_f32 v146, v146, v218
    v_mul_f32 v147, v147, v219
    v_mul_f32 v148, v148, v220
    v_mul_f32 v149, v149, v221
    v_mul_f32 v150, v150, v222
    v_mul_f32 v151, v151, v223
    v_cvt_pk_bf16_f32 v216, v144, v145
    ds_write_b32 v9, v216 offset:1088
    v_cvt_pk_bf16_f32 v218, v146, v147
    ds_write_b32 v9, v218 offset:1360
    v_cvt_pk_bf16_f32 v220, v148, v149
    ds_write_b32 v9, v220 offset:1632
    v_cvt_pk_bf16_f32 v222, v150, v151
    ds_write_b32 v9, v222 offset:1904
    v_fma_f32 v152, v152, v40, v42
    v_fma_f32 v153, v153, v41, v43
    v_fma_f32 v154, v154, v40, v42
    v_fma_f32 v155, v155, v41, v43
    v_fma_f32 v156, v156, v40, v42
    v_fma_f32 v157, v157, v41, v43
    v_fma_f32 v158, v158, v40, v42
    v_fma_f32 v159, v159, v41, v43
    v_fma_f32 v160, v160, v40, v42
    v_fma_f32 v161, v161, v41, v43
    v_exp_f32 v216, v152
    v_exp_f32 v217, v153
    v_exp_f32 v218, v154
    v_exp_f32 v219, v155
    v_exp_f32 v220, v156
    v_exp_f32 v221, v157
    v_exp_f32 v222, v158
    v_exp_f32 v223, v159
    v_exp_f32 v224, v160
    v_exp_f32 v225, v161
    buffer_load_dwordx4 a[20:23], v4, s[32:35], s69 offen offset:1024 sc1
    v_add_f32 v216, 1.0, v216
    v_add_f32 v217, 1.0, v217
    v_add_f32 v218, 1.0, v218
    v_add_f32 v219, 1.0, v219
    v_add_f32 v220, 1.0, v220
    v_add_f32 v221, 1.0, v221
    v_add_f32 v222, 1.0, v222
    v_add_f32 v223, 1.0, v223
    v_add_f32 v224, 1.0, v224
    v_add_f32 v225, 1.0, v225
    v_rcp_f32 v216, v216
    v_rcp_f32 v217, v217
    v_rcp_f32 v218, v218
    v_rcp_f32 v219, v219
    v_rcp_f32 v220, v220
    v_rcp_f32 v221, v221
    v_rcp_f32 v222, v222
    v_rcp_f32 v223, v223
    v_rcp_f32 v224, v224
    v_rcp_f32 v225, v225
    v_mul_f32 v152, v152, v216
    v_mul_f32 v153, v153, v217
    v_mul_f32 v154, v154, v218
    v_mul_f32 v155, v155, v219
    v_mul_f32 v156, v156, v220
    v_mul_f32 v157, v157, v221
    v_mul_f32 v158, v158, v222
    v_mul_f32 v159, v159, v223
    v_mul_f32 v160, v160, v224
    v_mul_f32 v161, v161, v225
    v_cvt_pk_bf16_f32 v216, v152, v153
    ds_write_b32 v10, v216 offset:0
    v_cvt_pk_bf16_f32 v218, v154, v155
    ds_write_b32 v10, v218 offset:272
    v_cvt_pk_bf16_f32 v220, v156, v157
    ds_write_b32 v10, v220 offset:544
    v_cvt_pk_bf16_f32 v222, v158, v159
    ds_write_b32 v10, v222 offset:816
    v_cvt_pk_bf16_f32 v224, v160, v161
    ds_write_b32 v11, v224 offset:0
    v_lshrrev_b32 v20, 5, v1
    v_lshlrev_b32 v20, 3, v20
    s_lshl_b32 s52, s40, 6
    v_add_u32 v20, s52, v20
    global_load_dwordx2 v[176:177], v20, s[16:17] offset:0
    global_load_dwordx2 v[184:185], v20, s[18:19] offset:0
    global_load_dwordx2 v[178:179], v20, s[16:17] offset:16
    global_load_dwordx2 v[186:187], v20, s[18:19] offset:16
    global_load_dwordx2 v[180:181], v20, s[16:17] offset:32
    global_load_dwordx2 v[188:189], v20, s[18:19] offset:32
    global_load_dwordx2 v[182:183], v20, s[16:17] offset:48
    global_load_dwordx2 v[190:191], v20, s[18:19] offset:48
    s_waitcnt vmcnt(20)
    s_waitcnt lgkmcnt(0)
    s_barrier
    ds_read_b128 v[192:195], v3 offset:0
    ds_read_b128 v[196:199], v3 offset:9248
    ds_read_b128 v[200:203], v3 offset:18496
    ds_read_b128 v[204:207], v3 offset:27744
    s_waitcnt vmcnt(13) lgkmcnt(3)
    v_mfma_f32_32x32x16_bf16 v[64:79], a[0:3], v[192:195], 0
    s_waitcnt lgkmcnt(2)
    ds_read_b128 v[208:211], v3 offset:36992
    buffer_load_dwordx4 a[24:27], v4, s[32:35], s69 offen offset:2048 sc1
    ds_read_b128 v[44:47], v6 offset:3072
    ds_read_b128 v[48:51], v6 offset:3168
    v_mul_f32 v40, s93, v28
    v_mfma_f32_32x32x16_bf16 v[80:95], a[0:3], v[196:199], 0
    s_waitcnt vmcnt(13)
    ds_read_b128 v[212:215], v3 offset:46240
    ds_read_b64 v[52:53], v7 offset:3072
    ds_read_b64 v[54:55], v7 offset:3168
    ds_read_u16_d16_hi v22, v8 offset:3072
    v_mul_f32 v41, s93, v29
    v_mfma_f32_32x32x16_bf16 v[64:79], a[4:7], v[196:199], v[64:79]
    s_waitcnt lgkmcnt(8)
    ds_read_u16_d16_hi v23, v8 offset:3168
    v_fma_f32 v42, -v40, s89, v30
    v_fma_f32 v43, -v41, s89, v31
    v_mfma_f32_32x32x16_bf16 v[80:95], a[4:7], v[200:203], v[80:95]
    s_waitcnt vmcnt(12)
    ds_read_b128 v[192:195], v3 offset:272
    buffer_load_dwordx4 a[28:31], v4, s[32:35], s69 offen offset:3072 sc1
    s_waitcnt lgkmcnt(7)
    v_lshlrev_b32 v216, 16, v44
    s_waitcnt lgkmcnt(6)
    v_lshlrev_b32 v217, 16, v48
    v_and_b32 v218, s47, v44
    v_mfma_f32_32x32x16_bf16 v[64:79], a[8:11], v[200:203], v[64:79]
    v_and_b32 v219, s47, v48
    v_fma_f32 v216, v216, v40, v42
    v_fma_f32 v217, v217, v41, v43
    v_fma_f32 v218, v218, v40, v42
    v_fma_f32 v219, v219, v41, v43
    v_mfma_f32_32x32x16_bf16 v[96:111], a[0:3], v[200:203], 0
    v_exp_f32 v220, v216
    v_exp_f32 v221, v217
    v_add_f32 v220, 1.0, v220
    v_mfma_f32_32x32x16_bf16 v[80:95], a[8:11], v[204:207], v[80:95]
    ds_read_b128 v[196:199], v3 offset:9520
    s_mov_b32 s69, 8192
    buffer_load_dwordx4 a[32:35], v4, s[32:35], s69 offen offset:0 sc1
    v_exp_f32 v222, v218
    v_mfma_f32_32x32x16_bf16 v[112:127], a[0:3], v[204:207], 0
    v_exp_f32 v223, v219
    v_add_f32 v221, 1.0, v221
    v_add_f32 v222, 1.0, v222
    v_add_f32 v223, 1.0, v223
    v_mfma_f32_32x32x16_bf16 v[96:111], a[4:7], v[204:207], v[96:111]
    v_rcp_f32 v220, v220
    v_rcp_f32 v221, v221
    v_mul_f32 v216, v216, v220
    v_mfma_f32_32x32x16_bf16 v[112:127], a[4:7], v[208:211], v[112:127]
    ds_read_b128 v[200:203], v3 offset:18768
    buffer_load_dwordx4 a[36:39], v4, s[32:35], s69 offen offset:1024 sc1
    v_rcp_f32 v222, v222
    v_mul_f32 v217, v217, v221
    v_mfma_f32_32x32x16_bf16 v[96:111], a[8:11], v[208:211], v[96:111]
    s_waitcnt lgkmcnt(7)
    v_rcp_f32 v223, v223
    v_mul_f32 v218, v218, v222
    v_mul_f32 v219, v219, v223
    v_cvt_pk_bf16_f32 v220, v216, v217
    v_mfma_f32_32x32x16_bf16 v[112:127], a[8:11], v[212:215], v[112:127]
    s_waitcnt vmcnt(14) lgkmcnt(2)
    ds_read_b128 v[204:207], v3 offset:28016
    ds_write_b32 v9, v220 offset:64
    v_cvt_pk_bf16_f32 v221, v218, v219
    v_lshlrev_b32 v224, 16, v45
    v_lshlrev_b32 v225, 16, v49
    v_mfma_f32_32x32x16_bf16 v[64:79], a[12:15], v[192:195], v[64:79]
    s_waitcnt lgkmcnt(3)
    ds_read_b128 v[208:211], v3 offset:37264
    buffer_load_dwordx4 a[40:43], v4, s[32:35], s69 offen offset:2048 sc1
    ds_write_b32 v9, v221 offset:336
    v_and_b32 v226, s47, v45
    v_and_b32 v227, s47, v49
    v_mfma_f32_32x32x16_bf16 v[80:95], a[12:15], v[196:199], v[80:95]
    s_waitcnt vmcnt(14)
    ds_read_b128 v[212:215], v3 offset:46512
    v_fma_f32 v224, v224, v40, v42
    v_fma_f32 v225, v225, v41, v43
    v_fma_f32 v226, v226, v40, v42
    v_fma_f32 v227, v227, v41, v43
    v_mfma_f32_32x32x16_bf16 v[64:79], a[16:19], v[196:199], v[64:79]
    s_waitcnt lgkmcnt(5)
    v_exp_f32 v228, v224
    v_exp_f32 v229, v225
    v_add_f32 v228, 1.0, v228
    v_mfma_f32_32x32x16_bf16 v[80:95], a[16:19], v[200:203], v[80:95]
    s_waitcnt vmcnt(13)
    ds_read_b128 v[192:195], v3 offset:544
    buffer_load_dwordx4 a[44:47], v4, s[32:35], s69 offen offset:3072 sc1
    v_exp_f32 v230, v226
    v_add_f32 v229, 1.0, v229
    v_mfma_f32_32x32x16_bf16 v[64:79], a[20:23], v[200:203], v[64:79]
    v_exp_f32 v231, v227
    v_add_f32 v230, 1.0, v230
    v_add_f32 v231, 1.0, v231
    v_lshlrev_b32 v216, 16, v46
    v_mfma_f32_32x32x16_bf16 v[96:111], a[12:15], v[200:203], v[96:111]
    s_waitcnt lgkmcnt(5)
    v_rcp_f32 v228, v228
    v_rcp_f32 v229, v229
    v_mul_f32 v224, v224, v228
    v_mfma_f32_32x32x16_bf16 v[80:95], a[20:23], v[204:207], v[80:95]
    ds_read_b128 v[196:199], v3 offset:9792
    s_mov_b32 s69, 12288
    buffer_load_dwordx4 a[48:51], v4, s[32:35], s69 offen offset:0 sc1
    v_rcp_f32 v230, v230
    v_mfma_f32_32x32x16_bf16 v[112:127], a[12:15], v[204:207], v[112:127]
    v_rcp_f32 v231, v231
    v_mul_f32 v225, v225, v229
    v_mul_f32 v226, v226, v230
    v_mul_f32 v227, v227, v231
    v_mfma_f32_32x32x16_bf16 v[96:111], a[16:19], v[204:207], v[96:111]
    s_waitcnt lgkmcnt(4)
    v_cvt_pk_bf16_f32 v228, v224, v225
    v_cvt_pk_bf16_f32 v229, v226, v227
    v_lshlrev_b32 v217, 16, v50
    v_and_b32 v218, s47, v46
    v_and_b32 v219, s47, v50
    v_mfma_f32_32x32x16_bf16 v[112:127], a[16:19], v[208:211], v[112:127]
    ds_read_b128 v[200:203], v3 offset:19040
    buffer_load_dwordx4 a[52:55], v4, s[32:35], s69 offen offset:1024 sc1
    ds_write_b32 v9, v228 offset:608
    ds_write_b32 v9, v229 offset:880
    v_fma_f32 v216, v216, v40, v42
    v_mfma_f32_32x32x16_bf16 v[96:111], a[20:23], v[208:211], v[96:111]
    s_waitcnt lgkmcnt(5)
    v_fma_f32 v217, v217, v41, v43
    v_fma_f32 v218, v218, v40, v42
    v_fma_f32 v219, v219, v41, v43
    v_exp_f32 v220, v216
    v_mfma_f32_32x32x16_bf16 v[112:127], a[20:23], v[212:215], v[112:127]
    s_waitcnt vmcnt(7) lgkmcnt(4)
    ds_read_b128 v[204:207], v3 offset:28288
    v_exp_f32 v221, v217
    v_exp_f32 v222, v218
    v_mfma_f32_32x32x16_bf16 v[64:79], a[24:27], v[192:195], v[64:79]
    s_waitcnt lgkmcnt(4)
    ds_read_b128 v[208:211], v3 offset:37536
    buffer_load_dwordx4 a[56:59], v4, s[32:35], s69 offen offset:2048 sc1
    v_exp_f32 v223, v219
    v_add_f32 v220, 1.0, v220
    v_mfma_f32_32x32x16_bf16 v[80:95], a[24:27], v[196:199], v[80:95]
    s_waitcnt vmcnt(7)
    ds_read_b128 v[212:215], v3 offset:46784
    v_add_f32 v221, 1.0, v221
    v_add_f32 v222, 1.0, v222
    v_add_f32 v223, 1.0, v223
    v_lshlrev_b32 v224, 16, v47
    v_mfma_f32_32x32x16_bf16 v[64:79], a[28:31], v[196:199], v[64:79]
    s_waitcnt lgkmcnt(5)
    v_rcp_f32 v220, v220
    v_rcp_f32 v221, v221
    v_mul_f32 v216, v216, v220
    v_mfma_f32_32x32x16_bf16 v[80:95], a[28:31], v[200:203], v[80:95]
    s_waitcnt vmcnt(6)
    ds_read_b128 v[192:195], v3 offset:32
    buffer_load_dwordx4 a[60:63], v4, s[32:35], s69 offen offset:3072 sc1
    v_rcp_f32 v222, v222
    v_mul_f32 v217, v217, v221
    v_mfma_f32_32x32x16_bf16 v[64:79], a[32:35], v[200:203], v[64:79]
    v_rcp_f32 v223, v223
    v_mul_f32 v218, v218, v222
    v_mul_f32 v219, v219, v223
    v_cvt_pk_bf16_f32 v220, v216, v217
    v_mfma_f32_32x32x16_bf16 v[96:111], a[24:27], v[200:203], v[96:111]
    s_waitcnt lgkmcnt(3)
    ds_write_b32 v9, v220 offset:1152
    v_cvt_pk_bf16_f32 v221, v218, v219
    v_lshlrev_b32 v225, 16, v51
    v_and_b32 v226, s47, v47
    v_and_b32 v227, s47, v51
    v_mfma_f32_32x32x16_bf16 v[80:95], a[32:35], v[204:207], v[80:95]
    ds_read_b128 v[196:199], v3 offset:9280
    s_mov_b32 s69, 16384
    buffer_load_dwordx4 a[64:67], v4, s[32:35], s69 offen offset:0 sc1
    s_add_u32 m0, s67, 3072
    s_nop 0
    buffer_load_dwordx4 v164, s[28:31], s62 offen lds
    s_add_u32 m0, s68, 3072
    v_mfma_f32_32x32x16_bf16 v[112:127], a[24:27], v[204:207], v[112:127]
    ds_write_b32 v9, v221 offset:1424
    v_fma_f32 v224, v224, v40, v42
    v_fma_f32 v225, v225, v41, v43
    v_fma_f32 v226, v226, v40, v42
    v_fma_f32 v227, v227, v41, v43
    v_mfma_f32_32x32x16_bf16 v[96:111], a[28:31], v[204:207], v[96:111]
    s_waitcnt lgkmcnt(5)
    v_exp_f32 v228, v224
    v_exp_f32 v229, v225
    v_add_f32 v228, 1.0, v228
    v_mfma_f32_32x32x16_bf16 v[112:127], a[28:31], v[208:211], v[112:127]
    ds_read_b128 v[200:203], v3 offset:18528
    buffer_load_dwordx4 a[68:71], v4, s[32:35], s69 offen offset:1024 sc1
    v_exp_f32 v230, v226
    v_add_f32 v229, 1.0, v229
    v_mfma_f32_32x32x16_bf16 v[96:111], a[32:35], v[208:211], v[96:111]
    s_waitcnt lgkmcnt(5)
    v_exp_f32 v231, v227
    v_add_f32 v230, 1.0, v230
    v_add_f32 v231, 1.0, v231
    v_lshlrev_b32 v216, 16, v52
    v_mfma_f32_32x32x16_bf16 v[112:127], a[32:35], v[212:215], v[112:127]
    s_waitcnt vmcnt(9) lgkmcnt(4)
    ds_read_b128 v[204:207], v3 offset:27776
    v_rcp_f32 v228, v228
    v_rcp_f32 v229, v229
    v_mfma_f32_32x32x16_bf16 v[64:79], a[36:39], v[192:195], v[64:79]
    s_waitcnt lgkmcnt(3)
    ds_read_b128 v[208:211], v3 offset:37024
    buffer_load_dwordx4 a[72:75], v4, s[32:35], s69 offen offset:2048 sc1
    v_rcp_f32 v230, v230
    v_mul_f32 v224, v224, v228
    v_mfma_f32_32x32x16_bf16 v[80:95], a[36:39], v[196:199], v[80:95]
    s_waitcnt vmcnt(9)
    ds_read_b128 v[212:215], v3 offset:46272
    buffer_load_dwordx4 v165, s[28:31], s63 offen lds
    s_add_u32 m0, s71, 3072
    v_rcp_f32 v231, v231
    v_mfma_f32_32x32x16_bf16 v[64:79], a[40:43], v[196:199], v[64:79]
    s_waitcnt lgkmcnt(3)
    v_mul_f32 v225, v225, v229
    v_mul_f32 v226, v226, v230
    v_mul_f32 v227, v227, v231
    v_cvt_pk_bf16_f32 v228, v224, v225
    v_cvt_pk_bf16_f32 v229, v226, v227
    v_mfma_f32_32x32x16_bf16 v[80:95], a[40:43], v[200:203], v[80:95]
    s_waitcnt vmcnt(9)
    ds_read_b128 v[192:195], v3 offset:304
    buffer_load_dwordx4 a[76:79], v4, s[32:35], s69 offen offset:3072 sc1
    ds_write_b32 v9, v228 offset:1696
    ds_write_b32 v9, v229 offset:1968
    v_lshlrev_b32 v217, 16, v54
    v_mfma_f32_32x32x16_bf16 v[64:79], a[44:47], v[200:203], v[64:79]
    v_and_b32 v218, s47, v52
    v_and_b32 v219, s47, v54
    v_fma_f32 v216, v216, v40, v42
    v_fma_f32 v217, v217, v41, v43
    v_fma_f32 v218, v218, v40, v42
    v_mfma_f32_32x32x16_bf16 v[96:111], a[36:39], v[200:203], v[96:111]
    s_waitcnt lgkmcnt(5)
    v_fma_f32 v219, v219, v41, v43
    v_exp_f32 v220, v216
    v_exp_f32 v221, v217
    v_mfma_f32_32x32x16_bf16 v[80:95], a[44:47], v[204:207], v[80:95]
    ds_read_b128 v[196:199], v3 offset:9552
    s_mov_b32 s69, 20480
    buffer_load_dwordx4 a[80:83], v4, s[32:35], s69 offen offset:0 sc1
    v_exp_f32 v222, v218
    v_mfma_f32_32x32x16_bf16 v[112:127], a[36:39], v[204:207], v[112:127]
    v_exp_f32 v223, v219
    v_add_f32 v220, 1.0, v220
    v_add_f32 v221, 1.0, v221
    v_add_f32 v222, 1.0, v222
    v_mfma_f32_32x32x16_bf16 v[96:111], a[40:43], v[204:207], v[96:111]
    s_waitcnt lgkmcnt(5)
    buffer_load_dwordx4 v166, s[28:31], s64 offen lds
    s_add_u32 m0, s84, 3072
    v_add_f32 v223, 1.0, v223
    v_rcp_f32 v220, v220
    v_mfma_f32_32x32x16_bf16 v[112:127], a[40:43], v[208:211], v[112:127]
    ds_read_b128 v[200:203], v3 offset:18800
    buffer_load_dwordx4 a[84:87], v4, s[32:35], s69 offen offset:1024 sc1
    v_rcp_f32 v221, v221
    v_mul_f32 v216, v216, v220
    v_mfma_f32_32x32x16_bf16 v[96:111], a[44:47], v[208:211], v[96:111]
    s_waitcnt lgkmcnt(5)
    v_rcp_f32 v222, v222
    v_rcp_f32 v223, v223
    v_mul_f32 v217, v217, v221
    v_mfma_f32_32x32x16_bf16 v[112:127], a[44:47], v[212:215], v[112:127]
    s_waitcnt vmcnt(12) lgkmcnt(4)
    ds_read_b128 v[204:207], v3 offset:28048
    v_mul_f32 v218, v218, v222
    v_mul_f32 v219, v219, v223
    v_cvt_pk_bf16_f32 v220, v216, v217
    v_cvt_pk_bf16_f32 v221, v218, v219
    v_mfma_f32_32x32x16_bf16 v[64:79], a[48:51], v[192:195], v[64:79]
    s_waitcnt lgkmcnt(2)
    ds_read_b128 v[208:211], v3 offset:37296
    buffer_load_dwordx4 a[88:91], v4, s[32:35], s69 offen offset:2048 sc1
    ds_write_b32 v10, v220 offset:64
    ds_write_b32 v10, v221 offset:336
    v_lshlrev_b32 v224, 16, v53
    v_mfma_f32_32x32x16_bf16 v[80:95], a[48:51], v[196:199], v[80:95]
    s_waitcnt vmcnt(12)
    ds_read_b128 v[212:215], v3 offset:46544
    v_lshlrev_b32 v225, 16, v55
    v_and_b32 v226, s47, v53
    v_and_b32 v227, s47, v55
    v_fma_f32 v224, v224, v40, v42
    v_mfma_f32_32x32x16_bf16 v[64:79], a[52:55], v[196:199], v[64:79]
    s_waitcnt lgkmcnt(5)
    v_fma_f32 v225, v225, v41, v43
    v_fma_f32 v226, v226, v40, v42
    v_fma_f32 v227, v227, v41, v43
    v_exp_f32 v228, v224
    v_mfma_f32_32x32x16_bf16 v[80:95], a[52:55], v[200:203], v[80:95]
    s_waitcnt vmcnt(11)
    ds_read_b128 v[192:195], v3 offset:576
    buffer_load_dwordx4 a[92:95], v4, s[32:35], s69 offen offset:3072 sc1
    buffer_load_dwordx4 v164, s[28:31], s65 offen lds
    s_add_u32 m0, s96, 3072
    v_add_f32 v228, 1.0, v228
    v_mfma_f32_32x32x16_bf16 v[64:79], a[56:59], v[200:203], v[64:79]
    v_exp_f32 v229, v225
    v_exp_f32 v230, v226
    v_add_f32 v229, 1.0, v229
    v_mfma_f32_32x32x16_bf16 v[96:111], a[48:51], v[200:203], v[96:111]
    s_waitcnt lgkmcnt(5)
    v_exp_f32 v231, v227
    v_add_f32 v230, 1.0, v230
    v_add_f32 v231, 1.0, v231
    v_fma_f32 v216, v22, v40, v42
    v_mfma_f32_32x32x16_bf16 v[80:95], a[56:59], v[204:207], v[80:95]
    ds_read_b128 v[196:199], v3 offset:9824
    s_mov_b32 s69, 24576
    buffer_load_dwordx4 a[96:99], v4, s[32:35], s69 offen offset:0 sc1
    v_rcp_f32 v228, v228
    v_mfma_f32_32x32x16_bf16 v[112:127], a[48:51], v[204:207], v[112:127]
    v_rcp_f32 v229, v229
    v_rcp_f32 v230, v230
    v_mul_f32 v224, v224, v228
    v_mfma_f32_32x32x16_bf16 v[96:111], a[52:55], v[204:207], v[96:111]
    s_waitcnt lgkmcnt(5)
    v_rcp_f32 v231, v231
    v_mul_f32 v225, v225, v229
    v_mul_f32 v226, v226, v230
    v_mul_f32 v227, v227, v231
    v_mfma_f32_32x32x16_bf16 v[112:127], a[52:55], v[208:211], v[112:127]
    ds_read_b128 v[200:203], v3 offset:19072
    buffer_load_dwordx4 a[100:103], v4, s[32:35], s69 offen offset:1024 sc1
    v_cvt_pk_bf16_f32 v228, v224, v225
    v_cvt_pk_bf16_f32 v229, v226, v227
    v_fma_f32 v217, v23, v41, v43
    v_mfma_f32_32x32x16_bf16 v[96:111], a[56:59], v[208:211], v[96:111]
    s_waitcnt lgkmcnt(3)
    buffer_load_dwordx4 v165, s[28:31], s66 offen lds
    ds_write_b32 v10, v228 offset:608
    ds_write_b32 v10, v229 offset:880
    v_exp_f32 v220, v216
    v_mfma_f32_32x32x16_bf16 v[112:127], a[56:59], v[212:215], v[112:127]
    s_waitcnt vmcnt(15) lgkmcnt(4)
    ds_read_b128 v[204:207], v3 offset:28320
    v_exp_f32 v221, v217
    v_add_f32 v220, 1.0, v220
    v_add_f32 v221, 1.0, v221
    v_rcp_f32 v220, v220
    v_rcp_f32 v221, v221
    v_mul_f32 v216, v216, v220
    v_mul_f32 v217, v217, v221
    v_cvt_pk_bf16_f32 v220, v216, v217
    ds_write_b32 v11, v220 offset:64
    v_mfma_f32_32x32x16_bf16 v[64:79], a[60:63], v[192:195], v[64:79]
    s_waitcnt lgkmcnt(5)
    ds_read_b128 v[208:211], v3 offset:37568
    buffer_load_dwordx4 a[104:107], v4, s[32:35], s69 offen offset:2048 sc1
    s_mov_b32 s61, 610304
    buffer_load_dwordx4 v[170:173], v2, s[32:35], s61 offen sc1
    v_mfma_f32_32x32x16_bf16 v[80:95], a[60:63], v[196:199], v[80:95]
    s_waitcnt vmcnt(16)
    ds_read_b128 v[212:215], v3 offset:46816
    v_mfma_f32_32x32x16_bf16 v[64:79], a[64:67], v[196:199], v[64:79]
    s_waitcnt lgkmcnt(6)
    s_waitcnt lgkmcnt(2)
    s_barrier
    v_mfma_f32_32x32x16_bf16 v[80:95], a[64:67], v[200:203], v[80:95]
    s_waitcnt vmcnt(14)
    ds_read_b128 v[192:195], v3 offset:64
    buffer_load_dwordx4 a[108:111], v4, s[32:35], s69 offen offset:3072 sc1
    ds_read_b128 v[44:47], v6 offset:6144
    ds_read_b128 v[48:51], v6 offset:6240
    v_mul_f32 v40, s94, v32
    v_mfma_f32_32x32x16_bf16 v[64:79], a[68:71], v[200:203], v[64:79]
    ds_read_b64 v[52:53], v7 offset:6144
    ds_read_b64 v[54:55], v7 offset:6240
    ds_read_u16_d16_hi v22, v8 offset:6144
    ds_read_u16_d16_hi v23, v8 offset:6240
    v_mul_f32 v41, s94, v33
    v_mfma_f32_32x32x16_bf16 v[96:111], a[60:63], v[200:203], v[96:111]
    v_fma_f32 v42, -v40, s90, v34
    v_fma_f32 v43, -v41, s90, v35
    v_mfma_f32_32x32x16_bf16 v[80:95], a[68:71], v[204:207], v[80:95]
    ds_read_b128 v[196:199], v3 offset:9312
    s_mov_b32 s69, 28672
    buffer_load_dwordx4 a[112:115], v4, s[32:35], s69 offen offset:0 sc1
    s_waitcnt lgkmcnt(6)
    v_lshlrev_b32 v216, 16, v44
    s_waitcnt lgkmcnt(5)
    v_lshlrev_b32 v217, 16, v48
    v_mfma_f32_32x32x16_bf16 v[112:127], a[60:63], v[204:207], v[112:127]
    v_and_b32 v218, s47, v44
    v_and_b32 v219, s47, v48
    v_fma_f32 v216, v216, v40, v42
    v_fma_f32 v217, v217, v41, v43
    v_fma_f32 v218, v218, v40, v42
    v_mfma_f32_32x32x16_bf16 v[96:111], a[64:67], v[204:207], v[96:111]
    v_fma_f32 v219, v219, v41, v43
    v_exp_f32 v220, v216
    v_exp_f32 v221, v217
    v_mfma_f32_32x32x16_bf16 v[112:127], a[64:67], v[208:211], v[112:127]
    ds_read_b128 v[200:203], v3 offset:18560
    buffer_load_dwordx4 a[116:119], v4, s[32:35], s69 offen offset:1024 sc1
    v_exp_f32 v222, v218
    v_add_f32 v220, 1.0, v220
    v_mfma_f32_32x32x16_bf16 v[96:111], a[68:71], v[208:211], v[96:111]
    v_exp_f32 v223, v219
    v_add_f32 v221, 1.0, v221
    v_add_f32 v222, 1.0, v222
    v_add_f32 v223, 1.0, v223
    v_mfma_f32_32x32x16_bf16 v[112:127], a[68:71], v[212:215], v[112:127]
    s_waitcnt vmcnt(16)
    ds_read_b128 v[204:207], v3 offset:27808
    v_rcp_f32 v220, v220
    v_rcp_f32 v221, v221
    v_mfma_f32_32x32x16_bf16 v[64:79], a[72:75], v[192:195], v[64:79]
    s_waitcnt lgkmcnt(2)
    ds_read_b128 v[208:211], v3 offset:37056
    buffer_load_dwordx4 a[120:123], v4, s[32:35], s69 offen offset:2048 sc1
    v_rcp_f32 v222, v222
    v_mul_f32 v216, v216, v220
    v_mfma_f32_32x32x16_bf16 v[80:95], a[72:75], v[196:199], v[80:95]
    s_waitcnt vmcnt(15)
    ds_read_b128 v[212:215], v3 offset:46304
    v_rcp_f32 v223, v223
    v_mul_f32 v217, v217, v221
    v_mul_f32 v218, v218, v222
    v_mfma_f32_32x32x16_bf16 v[64:79], a[76:79], v[196:199], v[64:79]
    s_waitcnt lgkmcnt(3)
    v_mul_f32 v219, v219, v223
    v_cvt_pk_bf16_f32 v220, v216, v217
    v_cvt_pk_bf16_f32 v221, v218, v219
    v_lshlrev_b32 v224, 16, v45
    v_lshlrev_b32 v225, 16, v49
    v_mfma_f32_32x32x16_bf16 v[80:95], a[76:79], v[200:203], v[80:95]
    s_waitcnt vmcnt(14)
    ds_read_b128 v[192:195], v3 offset:336
    buffer_load_dwordx4 a[124:127], v4, s[32:35], s69 offen offset:3072 sc1
    ds_write_b32 v9, v220 offset:128
    ds_write_b32 v9, v221 offset:400
    v_and_b32 v226, s47, v45
    v_mfma_f32_32x32x16_bf16 v[64:79], a[80:83], v[200:203], v[64:79]
    v_and_b32 v227, s47, v49
    v_fma_f32 v224, v224, v40, v42
    v_fma_f32 v225, v225, v41, v43
    v_fma_f32 v226, v226, v40, v42
    v_fma_f32 v227, v227, v41, v43
    v_mfma_f32_32x32x16_bf16 v[96:111], a[72:75], v[200:203], v[96:111]
    s_waitcnt lgkmcnt(5)
    v_exp_f32 v228, v224
    v_exp_f32 v229, v225
    v_add_f32 v228, 1.0, v228
    v_mfma_f32_32x32x16_bf16 v[80:95], a[80:83], v[204:207], v[80:95]
    ds_read_b128 v[196:199], v3 offset:9584
    s_mov_b32 s69, 32768
    buffer_load_dwordx4 a[128:131], v4, s[32:35], s69 offen offset:0 sc1
    v_exp_f32 v230, v226
    v_mfma_f32_32x32x16_bf16 v[112:127], a[72:75], v[204:207], v[112:127]
    v_exp_f32 v231, v227
    v_add_f32 v229, 1.0, v229
    v_add_f32 v230, 1.0, v230
    v_add_f32 v231, 1.0, v231
    v_mfma_f32_32x32x16_bf16 v[96:111], a[76:79], v[204:207], v[96:111]
    s_waitcnt lgkmcnt(5)
    v_rcp_f32 v228, v228
    v_rcp_f32 v229, v229
    v_mul_f32 v224, v224, v228
    v_mfma_f32_32x32x16_bf16 v[112:127], a[76:79], v[208:211], v[112:127]
    ds_read_b128 v[200:203], v3 offset:18832
    buffer_load_dwordx4 a[132:135], v4, s[32:35], s69 offen offset:1024 sc1
    v_rcp_f32 v230, v230
    v_mul_f32 v225, v225, v229
    v_mfma_f32_32x32x16_bf16 v[96:111], a[80:83], v[208:211], v[96:111]
    s_waitcnt lgkmcnt(5)
    v_rcp_f32 v231, v231
    v_mul_f32 v226, v226, v230
    v_mul_f32 v227, v227, v231
    v_cvt_pk_bf16_f32 v228, v224, v225
    v_mfma_f32_32x32x16_bf16 v[112:127], a[80:83], v[212:215], v[112:127]
    s_waitcnt vmcnt(15) lgkmcnt(4)
    ds_read_b128 v[204:207], v3 offset:28080
    ds_write_b32 v9, v228 offset:672
    v_cvt_pk_bf16_f32 v229, v226, v227
    v_lshlrev_b32 v216, 16, v46
    v_lshlrev_b32 v217, 16, v50
    v_mfma_f32_32x32x16_bf16 v[64:79], a[84:87], v[192:195], v[64:79]
    s_waitcnt lgkmcnt(3)
    ds_read_b128 v[208:211], v3 offset:37328
    buffer_load_dwordx4 a[136:139], v4, s[32:35], s69 offen offset:2048 sc1
    ds_write_b32 v9, v229 offset:944
    v_and_b32 v218, s47, v46
    v_and_b32 v219, s47, v50
    v_mfma_f32_32x32x16_bf16 v[80:95], a[84:87], v[196:199], v[80:95]
    s_waitcnt vmcnt(15)
    ds_read_b128 v[212:215], v3 offset:46576
    v_fma_f32 v216, v216, v40, v42
    v_fma_f32 v217, v217, v41, v43
    v_fma_f32 v218, v218, v40, v42
    v_fma_f32 v219, v219, v41, v43
    v_mfma_f32_32x32x16_bf16 v[64:79], a[88:91], v[196:199], v[64:79]
    s_waitcnt lgkmcnt(5)
    v_exp_f32 v220, v216
    v_exp_f32 v221, v217
    v_add_f32 v220, 1.0, v220
    v_mfma_f32_32x32x16_bf16 v[80:95], a[88:91], v[200:203], v[80:95]
    s_waitcnt vmcnt(14)
    ds_read_b128 v[192:195], v3 offset:608
    buffer_load_dwordx4 a[140:143], v4, s[32:35], s69 offen offset:3072 sc1
    v_exp_f32 v222, v218
    v_add_f32 v221, 1.0, v221
    v_mfma_f32_32x32x16_bf16 v[64:79], a[92:95], v[200:203], v[64:79]
    v_exp_f32 v223, v219
    v_add_f32 v222, 1.0, v222
    v_add_f32 v223, 1.0, v223
    v_lshlrev_b32 v224, 16, v47
    v_mfma_f32_32x32x16_bf16 v[96:111], a[84:87], v[200:203], v[96:111]
    s_waitcnt lgkmcnt(5)
    v_rcp_f32 v220, v220
    v_rcp_f32 v221, v221
    v_mul_f32 v216, v216, v220
    v_mfma_f32_32x32x16_bf16 v[80:95], a[92:95], v[204:207], v[80:95]
    ds_read_b128 v[196:199], v3 offset:9856
    s_mov_b32 s69, 36864
    buffer_load_dwordx4 a[144:147], v4, s[32:35], s69 offen offset:0 sc1
    v_rcp_f32 v222, v222
    v_mfma_f32_32x32x16_bf16 v[112:127], a[84:87], v[204:207], v[112:127]
    v_rcp_f32 v223, v223
    v_mul_f32 v217, v217, v221
    v_mul_f32 v218, v218, v222
    v_mul_f32 v219, v219, v223
    v_mfma_f32_32x32x16_bf16 v[96:111], a[88:91], v[204:207], v[96:111]
    s_waitcnt lgkmcnt(4)
    v_cvt_pk_bf16_f32 v220, v216, v217
    v_cvt_pk_bf16_f32 v221, v218, v219
    v_lshlrev_b32 v225, 16, v51
    v_and_b32 v226, s47, v47
    v_and_b32 v227, s47, v51
    v_mfma_f32_32x32x16_bf16 v[112:127], a[88:91], v[208:211], v[112:127]
    ds_read_b128 v[200:203], v3 offset:19104
    buffer_load_dwordx4 a[148:151], v4, s[32:35], s69 offen offset:1024 sc1
    ds_write_b32 v9, v220 offset:1216
    ds_write_b32 v9, v221 offset:1488
    v_fma_f32 v224, v224, v40, v42
    v_mfma_f32_32x32x16_bf16 v[96:111], a[92:95], v[208:211], v[96:111]
    s_waitcnt lgkmcnt(5)
    v_fma_f32 v225, v225, v41, v43
    v_fma_f32 v226, v226, v40, v42
    v_fma_f32 v227, v227, v41, v43
    v_exp_f32 v228, v224
    v_mfma_f32_32x32x16_bf16 v[112:127], a[92:95], v[212:215], v[112:127]
    s_waitcnt vmcnt(15) lgkmcnt(4)
    ds_read_b128 v[204:207], v3 offset:28352
    v_exp_f32 v229, v225
    v_exp_f32 v230, v226
    v_mfma_f32_32x32x16_bf16 v[64:79], a[96:99], v[192:195], v[64:79]
    s_waitcnt lgkmcnt(4)
    ds_read_b128 v[208:211], v3 offset:37600
    buffer_load_dwordx4 a[152:155], v4, s[32:35], s69 offen offset:2048 sc1
    v_exp_f32 v231, v227
    v_add_f32 v228, 1.0, v228
    v_mfma_f32_32x32x16_bf16 v[80:95], a[96:99], v[196:199], v[80:95]
    s_waitcnt vmcnt(15)
    ds_read_b128 v[212:215], v3 offset:46848
    v_add_f32 v229, 1.0, v229
    v_add_f32 v230, 1.0, v230
    v_add_f32 v231, 1.0, v231
    v_lshlrev_b32 v216, 16, v52
    v_mfma_f32_32x32x16_bf16 v[64:79], a[100:103], v[196:199], v[64:79]
    s_waitcnt lgkmcnt(5)
    v_rcp_f32 v228, v228
    v_rcp_f32 v229, v229
    v_mul_f32 v224, v224, v228
    v_mfma_f32_32x32x16_bf16 v[80:95], a[100:103], v[200:203], v[80:95]
    s_waitcnt vmcnt(13)
    ds_read_b128 v[192:195], v3 offset:96
    buffer_load_dwordx4 a[156:159], v4, s[32:35], s69 offen offset:3072 sc1
    v_rcp_f32 v230, v230
    v_mul_f32 v225, v225, v229
    v_mfma_f32_32x32x16_bf16 v[64:79], a[104:107], v[200:203], v[64:79]
    s_waitcnt vmcnt(13)
    v_xor_b32 v170, s60, v170
    v_xor_b32 v171, s60, v171
    v_xor_b32 v172, s60, v172
    v_xor_b32 v173, s60, v173
    v_or3_b32 v170, v170, v171, v172
    v_mfma_f32_32x32x16_bf16 v[96:111], a[96:99], v[200:203], v[96:111]
    s_waitcnt lgkmcnt(3)
    v_or_b32 v170, v170, v173
    v_cmp_ne_u32 vcc, 0, v170
    v_rcp_f32 v231, v231
    v_mul_f32 v226, v226, v230
    v_mfma_f32_32x32x16_bf16 v[80:95], a[104:107], v[204:207], v[80:95]
    ds_read_b128 v[196:199], v3 offset:9344
    s_mov_b32 s69, 40960
    buffer_load_dwordx4 a[160:163], v4, s[32:35], s69 offen offset:0 sc1
    s_cbranch_vccnz L_slowE
    L_backE:
    v_mul_f32 v227, v227, v231
    v_cvt_pk_bf16_f32 v228, v224, v225
    v_mfma_f32_32x32x16_bf16 v[112:127], a[96:99], v[204:207], v[112:127]
    ds_write_b32 v9, v228 offset:1760
    v_cvt_pk_bf16_f32 v229, v226, v227
    v_lshlrev_b32 v217, 16, v54
    v_and_b32 v218, s47, v52
    v_and_b32 v219, s47, v54
    v_mfma_f32_32x32x16_bf16 v[96:111], a[100:103], v[204:207], v[96:111]
    s_waitcnt lgkmcnt(4)
    ds_write_b32 v9, v229 offset:2032
    v_and_b32 v170, 31, v1
    v_lshrrev_b32 v171, 5, v1
    v_lshlrev_b32 v170, 2, v170
    v_lshl_add_u32 v172, v171, 7, v170
    v_mfma_f32_32x32x16_bf16 v[112:127], a[100:103], v[208:211], v[112:127]
    ds_read_b128 v[200:203], v3 offset:18592
    buffer_load_dwordx4 a[164:167], v4, s[32:35], s69 offen offset:1024 sc1
    buffer_load_dword v144, v172, s[32:35], s85 offen offset:0 sc1
    v_fma_f32 v216, v216, v40, v42
    v_fma_f32 v217, v217, v41, v43
    v_mfma_f32_32x32x16_bf16 v[96:111], a[104:107], v[208:211], v[96:111]
    s_waitcnt lgkmcnt(5)
    v_fma_f32 v218, v218, v40, v42
    v_fma_f32 v219, v219, v41, v43
    v_exp_f32 v220, v216
    v_lshlrev_b32 v224, 16, v53
    v_mfma_f32_32x32x16_bf16 v[112:127], a[104:107], v[212:215], v[112:127]
    s_waitcnt vmcnt(15) lgkmcnt(4)
    ds_read_b128 v[204:207], v3 offset:27840
    buffer_load_dword v145, v172, s[32:35], s85 offen offset:256 sc1
    v_exp_f32 v221, v217
    v_add_f32 v220, 1.0, v220
    v_mfma_f32_32x32x16_bf16 v[64:79], a[108:111], v[192:195], v[64:79]
    s_waitcnt lgkmcnt(4)
    ds_read_b128 v[208:211], v3 offset:37088
    buffer_load_dwordx4 a[168:171], v4, s[32:35], s69 offen offset:2048 sc1
    v_exp_f32 v222, v218
    v_add_f32 v221, 1.0, v221
    v_mfma_f32_32x32x16_bf16 v[80:95], a[108:111], v[196:199], v[80:95]
    s_waitcnt vmcnt(16)
    ds_read_b128 v[212:215], v3 offset:46336
    buffer_load_dword v146, v172, s[32:35], s85 offen offset:512 sc1
    v_exp_f32 v223, v219
    v_add_f32 v222, 1.0, v222
    v_mfma_f32_32x32x16_bf16 v[64:79], a[112:115], v[196:199], v[64:79]
    s_waitcnt lgkmcnt(3)
    v_add_f32 v223, 1.0, v223
    v_rcp_f32 v220, v220
    v_rcp_f32 v221, v221
    v_mfma_f32_32x32x16_bf16 v[80:95], a[112:115], v[200:203], v[80:95]
    s_waitcnt vmcnt(16)
    ds_read_b128 v[192:195], v3 offset:368
    buffer_load_dwordx4 a[172:175], v4, s[32:35], s69 offen offset:3072 sc1
    buffer_load_dword v147, v172, s[32:35], s85 offen offset:768 sc1
    v_rcp_f32 v222, v222
    v_mfma_f32_32x32x16_bf16 v[64:79], a[116:119], v[200:203], v[64:79]
    v_rcp_f32 v223, v223
    v_mul_f32 v216, v216, v220
    v_mul_f32 v217, v217, v221
    v_mul_f32 v218, v218, v222
    v_mfma_f32_32x32x16_bf16 v[96:111], a[108:111], v[200:203], v[96:111]
    s_waitcnt lgkmcnt(3)
    buffer_load_dword v148, v172, s[32:35], s85 offen offset:1024 sc1
    v_mul_f32 v219, v219, v223
    v_cvt_pk_bf16_f32 v220, v216, v217
    v_cvt_pk_bf16_f32 v221, v218, v219
    v_lshlrev_b32 v225, 16, v55
    v_mfma_f32_32x32x16_bf16 v[80:95], a[116:119], v[204:207], v[80:95]
    ds_read_b128 v[196:199], v3 offset:9616
    s_mov_b32 s69, 45056
    buffer_load_dwordx4 a[176:179], v4, s[32:35], s69 offen offset:0 sc1
    ds_write_b32 v10, v220 offset:128
    v_and_b32 v226, s47, v53
    v_mfma_f32_32x32x16_bf16 v[112:127], a[108:111], v[204:207], v[112:127]
    buffer_load_dword v149, v172, s[32:35], s85 offen offset:1280 sc1
    ds_write_b32 v10, v221 offset:400
    v_and_b32 v227, s47, v55
    v_fma_f32 v224, v224, v40, v42
    v_fma_f32 v225, v225, v41, v43
    v_mfma_f32_32x32x16_bf16 v[96:111], a[112:115], v[204:207], v[96:111]
    s_waitcnt lgkmcnt(5)
    v_fma_f32 v226, v226, v40, v42
    v_fma_f32 v227, v227, v41, v43
    v_exp_f32 v228, v224
    v_fma_f32 v216, v22, v40, v42
    v_mfma_f32_32x32x16_bf16 v[112:127], a[112:115], v[208:211], v[112:127]
    ds_read_b128 v[200:203], v3 offset:18864
    buffer_load_dwordx4 a[180:183], v4, s[32:35], s69 offen offset:1024 sc1
    buffer_load_dword v150, v172, s[32:35], s85 offen offset:1536 sc1
    v_exp_f32 v229, v225
    v_mfma_f32_32x32x16_bf16 v[96:111], a[116:119], v[208:211], v[96:111]
    s_waitcnt lgkmcnt(5)
    v_exp_f32 v230, v226
    v_exp_f32 v231, v227
    v_add_f32 v228, 1.0, v228
    v_mfma_f32_32x32x16_bf16 v[112:127], a[116:119], v[212:215], v[112:127]
    s_waitcnt vmcnt(22) lgkmcnt(4)
    ds_read_b128 v[204:207], v3 offset:28112
    buffer_load_dword v151, v172, s[32:35], s85 offen offset:1792 sc1
    v_add_f32 v229, 1.0, v229
    v_add_f32 v230, 1.0, v230
    v_add_f32 v231, 1.0, v231
    v_mfma_f32_32x32x16_bf16 v[64:79], a[120:123], v[192:195], v[64:79]
    s_waitcnt lgkmcnt(4)
    ds_read_b128 v[208:211], v3 offset:37360
    buffer_load_dwordx4 a[184:187], v4, s[32:35], s69 offen offset:2048 sc1
    v_rcp_f32 v228, v228
    v_fma_f32 v217, v23, v41, v43
    v_mfma_f32_32x32x16_bf16 v[80:95], a[120:123], v[196:199], v[80:95]
    s_waitcnt vmcnt(23)
    ds_read_b128 v[212:215], v3 offset:46608
    buffer_load_dword v152, v172, s[32:35], s85 offen offset:2048 sc1
    v_rcp_f32 v229, v229
    v_mul_f32 v224, v224, v228
    v_mfma_f32_32x32x16_bf16 v[64:79], a[124:127], v[196:199], v[64:79]
    s_waitcnt lgkmcnt(3)
    v_rcp_f32 v230, v230
    v_rcp_f32 v231, v231
    v_mul_f32 v225, v225, v229
    v_mfma_f32_32x32x16_bf16 v[80:95], a[124:127], v[200:203], v[80:95]
    s_waitcnt vmcnt(23)
    ds_read_b128 v[192:195], v3 offset:640
    buffer_load_dwordx4 a[188:191], v4, s[32:35], s69 offen offset:3072 sc1
    buffer_load_dword v153, v172, s[32:35], s85 offen offset:2304 sc1
    v_mul_f32 v226, v226, v230
    v_mul_f32 v227, v227, v231
    v_mfma_f32_32x32x16_bf16 v[64:79], a[128:131], v[200:203], v[64:79]
    v_cvt_pk_bf16_f32 v228, v224, v225
    v_cvt_pk_bf16_f32 v229, v226, v227
    v_exp_f32 v220, v216
    v_mfma_f32_32x32x16_bf16 v[96:111], a[120:123], v[200:203], v[96:111]
    s_waitcnt lgkmcnt(3)
    buffer_load_dword v154, v172, s[32:35], s85 offen offset:2560 sc1
    ds_write_b32 v10, v228 offset:672
    ds_write_b32 v10, v229 offset:944
    v_exp_f32 v221, v217
    v_mfma_f32_32x32x16_bf16 v[80:95], a[128:131], v[204:207], v[80:95]
    ds_read_b128 v[196:199], v3 offset:9888
    s_mov_b32 s69, 49152
    buffer_load_dwordx4 a[192:195], v4, s[32:35], s69 offen offset:0 sc1
    v_add_f32 v220, 1.0, v220
    v_add_f32 v221, 1.0, v221
    v_mfma_f32_32x32x16_bf16 v[112:127], a[120:123], v[204:207], v[112:127]
    buffer_load_dword v155, v172, s[32:35], s85 offen offset:2816 sc1
    v_rcp_f32 v220, v220
    v_rcp_f32 v221, v221
    v_mfma_f32_32x32x16_bf16 v[96:111], a[124:127], v[204:207], v[96:111]
    s_waitcnt lgkmcnt(5)
    s_mul_i32 s61, s40, 128
    v_mul_f32 v216, v216, v220
    v_mul_f32 v217, v217, v221
    v_cvt_pk_bf16_f32 v220, v216, v217
    v_mfma_f32_32x32x16_bf16 v[112:127], a[124:127], v[208:211], v[112:127]
    ds_read_b128 v[200:203], v3 offset:19136
    buffer_load_dwordx4 a[196:199], v4, s[32:35], s69 offen offset:1024 sc1
    buffer_load_dword v156, v172, s[32:35], s85 offen offset:3072 sc1
    ds_write_b32 v11, v220 offset:128
    v_mfma_f32_32x32x16_bf16 v[96:111], a[128:131], v[208:211], v[96:111]
    s_waitcnt lgkmcnt(6)
    v_mfma_f32_32x32x16_bf16 v[112:127], a[128:131], v[212:215], v[112:127]
    s_waitcnt vmcnt(29) lgkmcnt(5)
    ds_read_b128 v[204:207], v3 offset:28384
    buffer_load_dword v157, v172, s[32:35], s85 offen offset:3328 sc1
    v_mfma_f32_32x32x16_bf16 v[64:79], a[132:135], v[192:195], v[64:79]
    s_waitcnt lgkmcnt(3)
    ds_read_b128 v[208:211], v3 offset:37632
    buffer_load_dwordx4 a[200:203], v4, s[32:35], s69 offen offset:2048 sc1
    v_mfma_f32_32x32x16_bf16 v[80:95], a[132:135], v[196:199], v[80:95]
    s_waitcnt vmcnt(30)
    ds_read_b128 v[212:215], v3 offset:46880
    buffer_load_dword v158, v172, s[32:35], s85 offen offset:3584 sc1
    v_mfma_f32_32x32x16_bf16 v[64:79], a[136:139], v[196:199], v[64:79]
    s_waitcnt lgkmcnt(4)
    s_waitcnt lgkmcnt(3)
    s_barrier
    v_mfma_f32_32x32x16_bf16 v[80:95], a[136:139], v[200:203], v[80:95]
    s_waitcnt vmcnt(30)
    ds_read_b128 v[192:195], v3 offset:128
    buffer_load_dwordx4 a[204:207], v4, s[32:35], s69 offen offset:3072 sc1
    buffer_load_dword v159, v172, s[32:35], s85 offen offset:3840 sc1
    ds_read_b128 v[44:47], v6 offset:9216
    v_add_u32 v170, 131328, v170
    v_mfma_f32_32x32x16_bf16 v[64:79], a[140:143], v[200:203], v[64:79]
    ds_read_b128 v[48:51], v6 offset:9312
    ds_read_b64 v[52:53], v7 offset:9216
    ds_read_b64 v[54:55], v7 offset:9312
    ds_read_u16_d16_hi v22, v8 offset:9216
    v_add_u32 v170, s61, v170
    v_mfma_f32_32x32x16_bf16 v[96:111], a[132:135], v[200:203], v[96:111]
    s_waitcnt lgkmcnt(8)
    buffer_load_dword v160, v172, s[32:35], s86 offen offset:0 sc1
    ds_read_u16_d16_hi v23, v8 offset:9312
    v_lshlrev_b32 v171, 4, v171
    v_add_u32 v171, 131328, v171
    v_add_u32 v171, s61, v171
    v_mfma_f32_32x32x16_bf16 v[80:95], a[140:143], v[204:207], v[80:95]
    ds_read_b128 v[196:199], v3 offset:9376
    s_mov_b32 s69, 53248
    buffer_load_dwordx4 a[208:211], v4, s[32:35], s69 offen offset:0 sc1
    v_mul_f32 v40, s95, v36
    v_mul_f32 v41, s95, v37
    v_mfma_f32_32x32x16_bf16 v[112:127], a[132:135], v[204:207], v[112:127]
    buffer_load_dword v161, v172, s[32:35], s86 offen offset:256 sc1
    v_fma_f32 v42, -v40, s91, v38
    v_fma_f32 v43, -v41, s91, v39
    s_waitcnt lgkmcnt(6)
    v_lshlrev_b32 v216, 16, v44
    s_waitcnt lgkmcnt(5)
    v_lshlrev_b32 v217, 16, v48
    v_mfma_f32_32x32x16_bf16 v[96:111], a[136:139], v[204:207], v[96:111]
    v_and_b32 v218, s47, v44
    v_and_b32 v219, s47, v48
    v_fma_f32 v216, v216, v40, v42
    v_fma_f32 v217, v217, v41, v43
    v_fma_f32 v218, v218, v40, v42
    v_mfma_f32_32x32x16_bf16 v[112:127], a[136:139], v[208:211], v[112:127]
    ds_read_b128 v[200:203], v3 offset:18624
    buffer_load_dwordx4 a[212:215], v4, s[32:35], s69 offen offset:1024 sc1
    v_fma_f32 v219, v219, v41, v43
    v_exp_f32 v220, v216
    v_mfma_f32_32x32x16_bf16 v[96:111], a[140:143], v[208:211], v[96:111]
    v_exp_f32 v221, v217
    v_exp_f32 v222, v218
    v_add_f32 v220, 1.0, v220
    v_mfma_f32_32x32x16_bf16 v[112:127], a[140:143], v[212:215], v[112:127]
    s_waitcnt vmcnt(35)
    ds_read_b128 v[204:207], v3 offset:27872
    v_exp_f32 v223, v219
    v_add_f32 v221, 1.0, v221
    v_add_f32 v222, 1.0, v222
    v_mfma_f32_32x32x16_bf16 v[64:79], a[144:147], v[192:195], v[64:79]
    s_waitcnt lgkmcnt(2)
    ds_read_b128 v[208:211], v3 offset:37120
    buffer_load_dwordx4 a[0:3], v4, s[32:35], s69 offen offset:2048 sc1
    v_add_f32 v223, 1.0, v223
    v_rcp_f32 v220, v220
    v_mfma_f32_32x32x16_bf16 v[80:95], a[144:147], v[196:199], v[80:95]
    s_waitcnt vmcnt(35)
    ds_read_b128 v[212:215], v3 offset:46368
    v_rcp_f32 v221, v221
    v_rcp_f32 v222, v222
    v_mfma_f32_32x32x16_bf16 v[64:79], a[148:151], v[196:199], v[64:79]
    s_waitcnt lgkmcnt(3)
    v_rcp_f32 v223, v223
    v_mul_f32 v216, v216, v220
    v_mul_f32 v217, v217, v221
    v_mul_f32 v218, v218, v222
    v_mfma_f32_32x32x16_bf16 v[80:95], a[148:151], v[200:203], v[80:95]
    s_waitcnt vmcnt(34)
    ds_read_b128 v[192:195], v3 offset:400
    buffer_load_dwordx4 a[4:7], v4, s[32:35], s69 offen offset:3072 sc1
    v_mul_f32 v219, v219, v223
    v_cvt_pk_bf16_f32 v220, v216, v217
    v_cvt_pk_bf16_f32 v221, v218, v219
    v_mfma_f32_32x32x16_bf16 v[64:79], a[152:155], v[200:203], v[64:79]
    ds_write_b32 v9, v220 offset:192
    ds_write_b32 v9, v221 offset:464
    v_lshlrev_b32 v224, 16, v45
    v_lshlrev_b32 v225, 16, v49
    v_and_b32 v226, s47, v45
    v_mfma_f32_32x32x16_bf16 v[96:111], a[144:147], v[200:203], v[96:111]
    s_waitcnt lgkmcnt(5)
    v_and_b32 v227, s47, v49
    v_fma_f32 v224, v224, v40, v42
    v_fma_f32 v225, v225, v41, v43
    v_fma_f32 v226, v226, v40, v42
    v_fma_f32 v227, v227, v41, v43
    v_mfma_f32_32x32x16_bf16 v[80:95], a[152:155], v[204:207], v[80:95]
    ds_read_b128 v[196:199], v3 offset:9648
    s_mov_b32 s69, 57344
    buffer_load_dwordx4 a[8:11], v4, s[32:35], s69 offen offset:0 sc1
    v_exp_f32 v228, v224
    v_mfma_f32_32x32x16_bf16 v[112:127], a[144:147], v[204:207], v[112:127]
    v_exp_f32 v229, v225
    v_exp_f32 v230, v226
    v_add_f32 v228, 1.0, v228
    v_mfma_f32_32x32x16_bf16 v[96:111], a[148:151], v[204:207], v[96:111]
    s_waitcnt lgkmcnt(5)
    s_waitcnt vmcnt(31)
    v_add_f32 v144, v144, v145
    v_exp_f32 v231, v227
    v_add_f32 v229, 1.0, v229
    v_add_f32 v230, 1.0, v230
    v_mfma_f32_32x32x16_bf16 v[112:127], a[148:151], v[208:211], v[112:127]
    ds_read_b128 v[200:203], v3 offset:18896
    buffer_load_dwordx4 a[12:15], v4, s[32:35], s69 offen offset:1024 sc1
    v_add_f32 v231, 1.0, v231
    v_rcp_f32 v228, v228
    v_mfma_f32_32x32x16_bf16 v[96:111], a[152:155], v[208:211], v[96:111]
    s_waitcnt lgkmcnt(5)
    s_waitcnt vmcnt(30)
    v_add_f32 v144, v144, v146
    v_rcp_f32 v229, v229
    v_rcp_f32 v230, v230
    v_mfma_f32_32x32x16_bf16 v[112:127], a[152:155], v[212:215], v[112:127]
    s_waitcnt lgkmcnt(4)
    ds_read_b128 v[204:207], v3 offset:28144
    v_rcp_f32 v231, v231
    v_mul_f32 v224, v224, v228
    v_mul_f32 v225, v225, v229
    v_mfma_f32_32x32x16_bf16 v[64:79], a[156:159], v[192:195], v[64:79]
    s_waitcnt lgkmcnt(2)
    ds_read_b128 v[208:211], v3 offset:37392
    buffer_load_dwordx4 a[16:19], v4, s[32:35], s69 offen offset:2048 sc1
    s_waitcnt vmcnt(29)
    v_add_f32 v144, v144, v147
    v_mul_f32 v226, v226, v230
    v_mul_f32 v227, v227, v231
    v_mfma_f32_32x32x16_bf16 v[80:95], a[156:159], v[196:199], v[80:95]
    ds_read_b128 v[212:215], v3 offset:46640
    v_cvt_pk_bf16_f32 v228, v224, v225
    v_cvt_pk_bf16_f32 v229, v226, v227
    v_lshlrev_b32 v216, 16, v46
    v_lshlrev_b32 v217, 16, v50
    v_mfma_f32_32x32x16_bf16 v[64:79], a[160:163], v[196:199], v[64:79]
    s_waitcnt lgkmcnt(3)
    ds_write_b32 v9, v228 offset:736
    ds_write_b32 v9, v229 offset:1008
    s_waitcnt vmcnt(28)
    v_add_f32 v144, v144, v148
    v_and_b32 v218, s47, v46
    v_and_b32 v219, s47, v50
    v_mfma_f32_32x32x16_bf16 v[80:95], a[160:163], v[200:203], v[80:95]
    ds_read_b128 v[192:195], v3 offset:672
    buffer_load_dwordx4 a[20:23], v4, s[32:35], s69 offen offset:3072 sc1
    v_fma_f32 v216, v216, v40, v42
    v_fma_f32 v217, v217, v41, v43
    v_fma_f32 v218, v218, v40, v42
    v_mfma_f32_32x32x16_bf16 v[64:79], a[164:167], v[200:203], v[64:79]
    s_waitcnt vmcnt(27)
    v_add_f32 v144, v144, v149
    v_fma_f32 v219, v219, v41, v43
    v_exp_f32 v220, v216
    v_lshlrev_b32 v224, 16, v47
    v_mfma_f32_32x32x16_bf16 v[96:111], a[156:159], v[200:203], v[96:111]
    s_waitcnt lgkmcnt(5)
    v_exp_f32 v221, v217
    v_exp_f32 v222, v218
    v_add_f32 v220, 1.0, v220
    v_mfma_f32_32x32x16_bf16 v[80:95], a[164:167], v[204:207], v[80:95]
    ds_read_b128 v[196:199], v3 offset:9920
    s_mov_b32 s69, 61440
    buffer_load_dwordx4 a[24:27], v4, s[32:35], s69 offen offset:0 sc1
    s_waitcnt vmcnt(26)
    v_add_f32 v144, v144, v150
    v_add_f32 v221, 1.0, v221
    v_mfma_f32_32x32x16_bf16 v[112:127], a[156:159], v[204:207], v[112:127]
    v_exp_f32 v223, v219
    v_add_f32 v222, 1.0, v222
    v_add_f32 v223, 1.0, v223
    v_lshlrev_b32 v225, 16, v51
    v_mfma_f32_32x32x16_bf16 v[96:111], a[160:163], v[204:207], v[96:111]
    s_waitcnt lgkmcnt(5)
    s_waitcnt vmcnt(25)
    v_add_f32 v144, v144, v151
    v_rcp_f32 v220, v220
    v_rcp_f32 v221, v221
    v_mfma_f32_32x32x16_bf16 v[112:127], a[160:163], v[208:211], v[112:127]
    ds_read_b128 v[200:203], v3 offset:19168
    buffer_load_dwordx4 a[28:31], v4, s[32:35], s69 offen offset:1024 sc1
    v_rcp_f32 v222, v222
    v_mul_f32 v216, v216, v220
    v_mfma_f32_32x32x16_bf16 v[96:111], a[164:167], v[208:211], v[96:111]
    s_waitcnt lgkmcnt(5)
    s_waitcnt vmcnt(24)
    v_add_f32 v144, v144, v152
    v_rcp_f32 v223, v223
    v_mul_f32 v217, v217, v221
    v_mul_f32 v218, v218, v222
    v_mfma_f32_32x32x16_bf16 v[112:127], a[164:167], v[212:215], v[112:127]
    s_waitcnt lgkmcnt(2)
    ds_read_b128 v[204:207], v3 offset:28416
    v_mul_f32 v219, v219, v223
    v_cvt_pk_bf16_f32 v220, v216, v217
    v_cvt_pk_bf16_f32 v221, v218, v219
    v_and_b32 v226, s47, v47
    v_mfma_f32_32x32x16_bf16 v[64:79], a[168:171], v[192:195], v[64:79]
    s_waitcnt lgkmcnt(2)
    ds_read_b128 v[208:211], v3 offset:37664
    buffer_load_dwordx4 a[32:35], v4, s[32:35], s69 offen offset:2048 sc1
    ds_write_b32 v9, v220 offset:1280
    ds_write_b32 v9, v221 offset:1552
    s_waitcnt vmcnt(23)
    v_add_f32 v144, v144, v153
    v_mfma_f32_32x32x16_bf16 v[80:95], a[168:171], v[196:199], v[80:95]
    ds_read_b128 v[212:215], v3 offset:46912
    v_and_b32 v227, s47, v51
    v_fma_f32 v224, v224, v40, v42
    v_fma_f32 v225, v225, v41, v43
    v_fma_f32 v226, v226, v40, v42
    v_mfma_f32_32x32x16_bf16 v[64:79], a[172:175], v[196:199], v[64:79]
    s_waitcnt lgkmcnt(5)
    s_waitcnt vmcnt(22)
    v_add_f32 v144, v144, v154
    v_fma_f32 v227, v227, v41, v43
    v_exp_f32 v228, v224
    v_lshlrev_b32 v216, 16, v52
    v_mfma_f32_32x32x16_bf16 v[80:95], a[172:175], v[200:203], v[80:95]
    ds_read_b128 v[192:195], v3 offset:160
    buffer_load_dwordx4 a[36:39], v4, s[32:35], s69 offen offset:3072 sc1
    v_exp_f32 v229, v225
    v_add_f32 v228, 1.0, v228
    v_mfma_f32_32x32x16_bf16 v[64:79], a[176:179], v[200:203], v[64:79]
    s_waitcnt vmcnt(21)
    v_add_f32 v144, v144, v155
    v_exp_f32 v230, v226
    v_exp_f32 v231, v227
    v_mfma_f32_32x32x16_bf16 v[96:111], a[168:171], v[200:203], v[96:111]
    s_waitcnt lgkmcnt(5)
    v_add_f32 v229, 1.0, v229
    v_add_f32 v230, 1.0, v230
    v_add_f32 v231, 1.0, v231
    v_rcp_f32 v228, v228
    v_mfma_f32_32x32x16_bf16 v[80:95], a[176:179], v[204:207], v[80:95]
    ds_read_b128 v[196:199], v3 offset:9408
    s_mov_b32 s69, 65536
    buffer_load_dwordx4 a[40:43], v4, s[32:35], s69 offen offset:0 sc1
    s_waitcnt vmcnt(20)
    v_add_f32 v144, v144, v156
    v_mul_f32 v224, v224, v228
    v_mfma_f32_32x32x16_bf16 v[112:127], a[168:171], v[204:207], v[112:127]
    v_rcp_f32 v229, v229
    v_rcp_f32 v230, v230
    v_mul_f32 v225, v225, v229
    v_mfma_f32_32x32x16_bf16 v[96:111], a[172:175], v[204:207], v[96:111]
    s_waitcnt lgkmcnt(5)
    s_waitcnt vmcnt(19)
    v_add_f32 v144, v144, v157
    v_rcp_f32 v231, v231
    v_mul_f32 v226, v226, v230
    v_mul_f32 v227, v227, v231
    v_mfma_f32_32x32x16_bf16 v[112:127], a[172:175], v[208:211], v[112:127]
    ds_read_b128 v[200:203], v3 offset:18656
    buffer_load_dwordx4 a[44:47], v4, s[32:35], s69 offen offset:1024 sc1
    v_cvt_pk_bf16_f32 v228, v224, v225
    v_cvt_pk_bf16_f32 v229, v226, v227
    v_lshlrev_b32 v217, 16, v54
    v_mfma_f32_32x32x16_bf16 v[96:111], a[176:179], v[208:211], v[96:111]
    s_waitcnt lgkmcnt(3)
    ds_write_b32 v9, v228 offset:1824
    ds_write_b32 v9, v229 offset:2096
    s_waitcnt vmcnt(18)
    v_add_f32 v144, v144, v158
    v_and_b32 v218, s47, v52
    v_and_b32 v219, s47, v54
    v_mfma_f32_32x32x16_bf16 v[112:127], a[176:179], v[212:215], v[112:127]
    s_waitcnt lgkmcnt(4)
    ds_read_b128 v[204:207], v3 offset:27904
    v_fma_f32 v216, v216, v40, v42
    v_fma_f32 v217, v217, v41, v43
    v_fma_f32 v218, v218, v40, v42
    v_fma_f32 v219, v219, v41, v43
    v_mfma_f32_32x32x16_bf16 v[64:79], a[180:183], v[192:195], v[64:79]
    s_waitcnt lgkmcnt(4)
    ds_read_b128 v[208:211], v3 offset:37152
    buffer_load_dwordx4 a[48:51], v4, s[32:35], s69 offen offset:2048 sc1
    s_waitcnt vmcnt(17)
    v_add_f32 v144, v144, v159
    v_exp_f32 v220, v216
    v_mfma_f32_32x32x16_bf16 v[80:95], a[180:183], v[196:199], v[80:95]
    ds_read_b128 v[212:215], v3 offset:46400
    v_exp_f32 v221, v217
    v_exp_f32 v222, v218
    v_mfma_f32_32x32x16_bf16 v[64:79], a[184:187], v[196:199], v[64:79]
    s_waitcnt lgkmcnt(5)
    s_waitcnt vmcnt(16)
    v_add_f32 v144, v144, v160
    v_exp_f32 v223, v219
    v_add_f32 v220, 1.0, v220
    v_add_f32 v221, 1.0, v221
    v_mfma_f32_32x32x16_bf16 v[80:95], a[184:187], v[200:203], v[80:95]
    ds_read_b128 v[192:195], v3 offset:432
    buffer_load_dwordx4 a[52:55], v4, s[32:35], s69 offen offset:3072 sc1
    v_add_f32 v222, 1.0, v222
    v_add_f32 v223, 1.0, v223
    v_lshlrev_b32 v224, 16, v53
    v_mfma_f32_32x32x16_bf16 v[64:79], a[188:191], v[200:203], v[64:79]
    s_waitcnt vmcnt(15)
    v_add_f32 v144, v144, v161
    v_mov_b32 v173, v144
    s_nop 1
    v_permlane32_swap_b32 v144, v173
    v_add_f32 v144, v144, v173
    v_mul_f32 v144, 0xbfb8aa3b, v144
    v_mfma_f32_32x32x16_bf16 v[96:111], a[180:183], v[200:203], v[96:111]
    s_waitcnt lgkmcnt(3)
    ds_write_b32 v170, v144
    v_rcp_f32 v220, v220
    v_rcp_f32 v221, v221
    v_mfma_f32_32x32x16_bf16 v[80:95], a[188:191], v[204:207], v[80:95]
    ds_read_b128 v[196:199], v3 offset:9680
    s_mov_b32 s69, 69632
    buffer_load_dwordx4 a[56:59], v4, s[32:35], s69 offen offset:0 sc1
    v_rcp_f32 v222, v222
    v_mfma_f32_32x32x16_bf16 v[112:127], a[180:183], v[204:207], v[112:127]
    ds_read_b128 v[128:131], v171 offset:0
    v_rcp_f32 v223, v223
    v_mul_f32 v216, v216, v220
    v_mul_f32 v217, v217, v221
    v_mfma_f32_32x32x16_bf16 v[96:111], a[184:187], v[204:207], v[96:111]
    s_waitcnt lgkmcnt(5)
    v_mul_f32 v218, v218, v222
    v_mul_f32 v219, v219, v223
    v_cvt_pk_bf16_f32 v220, v216, v217
    v_cvt_pk_bf16_f32 v221, v218, v219
    v_lshlrev_b32 v225, 16, v55
    v_mfma_f32_32x32x16_bf16 v[112:127], a[184:187], v[208:211], v[112:127]
    ds_read_b128 v[200:203], v3 offset:18928
    buffer_load_dwordx4 a[60:63], v4, s[32:35], s69 offen offset:1024 sc1
    ds_read_b128 v[132:135], v171 offset:32
    ds_write_b32 v10, v220 offset:192
    v_and_b32 v226, s47, v53
    v_mfma_f32_32x32x16_bf16 v[96:111], a[188:191], v[208:211], v[96:111]
    s_waitcnt lgkmcnt(7)
    ds_write_b32 v10, v221 offset:464
    v_and_b32 v227, s47, v55
    v_fma_f32 v224, v224, v40, v42
    v_fma_f32 v225, v225, v41, v43
    v_fma_f32 v226, v226, v40, v42
    v_mfma_f32_32x32x16_bf16 v[112:127], a[188:191], v[212:215], v[112:127]
    s_waitcnt lgkmcnt(7)
    ds_read_b128 v[204:207], v3 offset:28176
    ds_read_b128 v[136:139], v171 offset:64
    v_fma_f32 v227, v227, v41, v43
    v_exp_f32 v228, v224
    v_mfma_f32_32x32x16_bf16 v[64:79], a[192:195], v[192:195], v[64:79]
    s_waitcnt lgkmcnt(7)
    ds_read_b128 v[208:211], v3 offset:37424
    buffer_load_dwordx4 a[64:67], v4, s[32:35], s69 offen offset:2048 sc1
    v_exp_f32 v229, v225
    v_add_f32 v228, 1.0, v228
    v_mfma_f32_32x32x16_bf16 v[80:95], a[192:195], v[196:199], v[80:95]
    ds_read_b128 v[212:215], v3 offset:46672
    ds_read_b128 v[140:143], v171 offset:96
    v_exp_f32 v230, v226
    v_add_f32 v229, 1.0, v229
    v_mfma_f32_32x32x16_bf16 v[64:79], a[196:199], v[196:199], v[64:79]
    s_waitcnt lgkmcnt(8)
    v_exp_f32 v231, v227
    v_add_f32 v230, 1.0, v230
    v_add_f32 v231, 1.0, v231
    v_fma_f32 v216, v22, v40, v42
    v_mfma_f32_32x32x16_bf16 v[80:95], a[196:199], v[200:203], v[80:95]
    ds_read_b128 v[192:195], v3 offset:704
    buffer_load_dwordx4 a[68:71], v4, s[32:35], s69 offen offset:3072 sc1
    v_rcp_f32 v228, v228
    v_fma_f32 v217, v23, v41, v43
    v_mfma_f32_32x32x16_bf16 v[64:79], a[200:203], v[200:203], v[64:79]
    v_rcp_f32 v229, v229
    v_rcp_f32 v230, v230
    v_mul_f32 v224, v224, v228
    v_mfma_f32_32x32x16_bf16 v[96:111], a[192:195], v[200:203], v[96:111]
    s_waitcnt lgkmcnt(5)
    v_rcp_f32 v231, v231
    v_mul_f32 v225, v225, v229
    v_mul_f32 v226, v226, v230
    v_mul_f32 v227, v227, v231
    v_mfma_f32_32x32x16_bf16 v[80:95], a[200:203], v[204:207], v[80:95]
    ds_read_b128 v[196:199], v3 offset:9952
    v_cvt_pk_bf16_f32 v228, v224, v225
    v_cvt_pk_bf16_f32 v229, v226, v227
    v_exp_f32 v220, v216
    v_mfma_f32_32x32x16_bf16 v[112:127], a[192:195], v[204:207], v[112:127]
    ds_write_b32 v10, v228 offset:736
    ds_write_b32 v10, v229 offset:1008
    v_exp_f32 v221, v217
    v_add_f32 v220, 1.0, v220
    v_mfma_f32_32x32x16_bf16 v[96:111], a[196:199], v[204:207], v[96:111]
    s_waitcnt lgkmcnt(6)
    v_add_f32 v221, 1.0, v221
    v_rcp_f32 v220, v220
    v_rcp_f32 v221, v221
    v_mfma_f32_32x32x16_bf16 v[112:127], a[196:199], v[208:211], v[112:127]
    ds_read_b128 v[200:203], v3 offset:19200
    v_mul_f32 v216, v216, v220
    v_mul_f32 v217, v217, v221
    v_cvt_pk_bf16_f32 v220, v216, v217
    v_mfma_f32_32x32x16_bf16 v[96:111], a[200:203], v[208:211], v[96:111]
    s_waitcnt lgkmcnt(6)
    ds_write_b32 v11, v220 offset:192
    v_mfma_f32_32x32x16_bf16 v[112:127], a[200:203], v[212:215], v[112:127]
    s_waitcnt lgkmcnt(5)
    ds_read_b128 v[204:207], v3 offset:28448
    v_mfma_f32_32x32x16_bf16 v[64:79], a[204:207], v[192:195], v[64:79]
    s_waitcnt lgkmcnt(5)
    ds_read_b128 v[208:211], v3 offset:37696
    v_mfma_f32_32x32x16_bf16 v[80:95], a[204:207], v[196:199], v[80:95]
    ds_read_b128 v[212:215], v3 offset:46944
    v_mfma_f32_32x32x16_bf16 v[64:79], a[208:211], v[196:199], v[64:79]
    s_waitcnt lgkmcnt(4)
    s_waitcnt lgkmcnt(3)
    s_barrier
    v_mfma_f32_32x32x16_bf16 v[80:95], a[208:211], v[200:203], v[80:95]
    s_waitcnt vmcnt(18)
    ds_read_b128 v[192:195], v3 offset:192
    v_mfma_f32_32x32x16_bf16 v[64:79], a[212:215], v[200:203], v[64:79]
    v_mfma_f32_32x32x16_bf16 v[96:111], a[204:207], v[200:203], v[96:111]
    s_waitcnt lgkmcnt(3)
    v_mfma_f32_32x32x16_bf16 v[80:95], a[212:215], v[204:207], v[80:95]
    ds_read_b128 v[196:199], v3 offset:464
    s_nop 7
    v_add_f32 v64, v64, v128
    v_add_f32 v65, v65, v129
    v_add_f32 v66, v66, v130
    v_add_f32 v67, v67, v131
    v_mfma_f32_32x32x16_bf16 v[112:127], a[204:207], v[204:207], v[112:127]
    v_add_f32 v68, v68, v132
    v_add_f32 v69, v69, v133
    v_add_f32 v70, v70, v134
    v_add_f32 v71, v71, v135
    v_add_f32 v72, v72, v136
    v_mfma_f32_32x32x16_bf16 v[96:111], a[208:211], v[204:207], v[96:111]
    s_waitcnt lgkmcnt(3)
    v_add_f32 v73, v73, v137
    v_add_f32 v74, v74, v138
    v_add_f32 v75, v75, v139
    v_add_f32 v76, v76, v140
    v_add_f32 v77, v77, v141
    v_mfma_f32_32x32x16_bf16 v[112:127], a[208:211], v[208:211], v[112:127]
    ds_read_b128 v[200:203], v3 offset:736
    v_add_f32 v78, v78, v142
    v_add_f32 v79, v79, v143
    v_mfma_f32_32x32x16_bf16 v[96:111], a[212:215], v[208:211], v[96:111]
    s_waitcnt lgkmcnt(3)
    v_mfma_f32_32x32x16_bf16 v[112:127], a[212:215], v[212:215], v[112:127]
    s_waitcnt vmcnt(17) lgkmcnt(2)
    ds_read_b128 v[204:207], v3 offset:224
    v_mfma_f32_32x32x16_bf16 v[64:79], a[0:3], v[192:195], v[64:79]
    s_waitcnt vmcnt(14) lgkmcnt(2)
    ds_read_b128 v[208:211], v3 offset:496
    s_mov_b32 s69, 299008
    buffer_load_dwordx4 a[88:91], v4, s[32:35], s69 offen offset:0 sc1
    v_add_f32 v80, v80, v128
    v_add_f32 v81, v81, v129
    v_mfma_f32_32x32x16_bf16 v[64:79], a[12:15], v[196:199], v[64:79]
    s_waitcnt vmcnt(12) lgkmcnt(2)
    ds_read_b128 v[212:215], v3 offset:768
    v_add_f32 v82, v82, v130
    v_add_f32 v83, v83, v131
    v_add_f32 v84, v84, v132
    v_add_f32 v85, v85, v133
    v_mfma_f32_32x32x16_bf16 v[64:79], a[24:27], v[200:203], v[64:79]
    s_waitcnt vmcnt(9) lgkmcnt(2)
    ds_read_b128 v[192:195], v3 offset:9440
    v_add_f32 v86, v86, v134
    v_add_f32 v87, v87, v135
    v_add_f32 v88, v88, v136
    v_add_f32 v89, v89, v137
    v_mfma_f32_32x32x16_bf16 v[64:79], a[36:39], v[204:207], v[64:79]
    s_waitcnt vmcnt(6) lgkmcnt(2)
    ds_read_b128 v[196:199], v3 offset:9712
    s_mov_b32 s69, 294912
    buffer_load_dwordx4 a[84:87], v4, s[32:35], s69 offen offset:3072 sc1
    v_add_f32 v90, v90, v138
    v_add_f32 v91, v91, v139
    v_mfma_f32_32x32x16_bf16 v[64:79], a[48:51], v[208:211], v[64:79]
    s_waitcnt vmcnt(4) lgkmcnt(2)
    ds_read_b128 v[200:203], v3 offset:9984
    v_add_f32 v92, v92, v140
    v_add_f32 v93, v93, v141
    v_add_f32 v94, v94, v142
    v_add_f32 v95, v95, v143
    v_mfma_f32_32x32x16_bf16 v[64:79], a[60:63], v[212:215], v[64:79]
    s_waitcnt lgkmcnt(2)
    ds_read_b128 v[204:207], v3 offset:9472
    v_mfma_f32_32x32x16_bf16 v[64:79], a[4:7], v[192:195], v[64:79]
    ds_read_b128 v[208:211], v3 offset:9744
    s_mov_b32 s69, 299008
    buffer_load_dwordx4 a[92:95], v4, s[32:35], s69 offen offset:1024 sc1
    v_mfma_f32_32x32x16_bf16 v[80:95], a[0:3], v[192:195], v[80:95]
    s_waitcnt lgkmcnt(3)
    v_add_f32 v96, v96, v128
    v_add_f32 v97, v97, v129
    v_add_f32 v98, v98, v130
    v_add_f32 v99, v99, v131
    v_add_f32 v100, v100, v132
    v_mfma_f32_32x32x16_bf16 v[64:79], a[16:19], v[196:199], v[64:79]
    ds_read_b128 v[212:215], v3 offset:10016
    v_add_f32 v101, v101, v133
    v_add_f32 v102, v102, v134
    v_add_f32 v103, v103, v135
    v_add_f32 v104, v104, v136
    v_mfma_f32_32x32x16_bf16 v[80:95], a[12:15], v[196:199], v[80:95]
    s_waitcnt lgkmcnt(3)
    v_add_f32 v105, v105, v137
    v_add_f32 v106, v106, v138
    v_add_f32 v107, v107, v139
    v_add_f32 v108, v108, v140
    v_add_f32 v109, v109, v141
    v_mfma_f32_32x32x16_bf16 v[64:79], a[28:31], v[200:203], v[64:79]
    ds_read_b128 v[192:195], v3 offset:18688
    s_mov_b32 s69, 307200
    buffer_load_dwordx4 a[124:127], v4, s[32:35], s69 offen offset:1024 sc1
    v_add_f32 v110, v110, v142
    v_add_f32 v111, v111, v143
    v_mfma_f32_32x32x16_bf16 v[80:95], a[24:27], v[200:203], v[80:95]
    s_waitcnt lgkmcnt(3)
    v_mfma_f32_32x32x16_bf16 v[64:79], a[40:43], v[204:207], v[64:79]
    ds_read_b128 v[196:199], v3 offset:18960
    v_mfma_f32_32x32x16_bf16 v[80:95], a[36:39], v[204:207], v[80:95]
    s_waitcnt lgkmcnt(3)
    buffer_load_dwordx4 a[120:123], v4, s[32:35], s69 offen offset:0 sc1
    v_mfma_f32_32x32x16_bf16 v[64:79], a[52:55], v[208:211], v[64:79]
    ds_read_b128 v[200:203], v3 offset:19232
    v_mfma_f32_32x32x16_bf16 v[80:95], a[48:51], v[208:211], v[80:95]
    s_waitcnt vmcnt(6) lgkmcnt(3)
    v_mfma_f32_32x32x16_bf16 v[64:79], a[64:67], v[212:215], v[64:79]
    ds_read_b128 v[204:207], v3 offset:18720
    buffer_load_dwordx4 a[128:131], v4, s[32:35], s69 offen offset:2048 sc1
    v_mfma_f32_32x32x16_bf16 v[80:95], a[60:63], v[212:215], v[80:95]
    s_waitcnt lgkmcnt(3)
    v_mfma_f32_32x32x16_bf16 v[64:79], a[8:11], v[192:195], v[64:79]
    ds_read_b128 v[208:211], v3 offset:18992
    v_mfma_f32_32x32x16_bf16 v[80:95], a[4:7], v[192:195], v[80:95]
    v_mfma_f32_32x32x16_bf16 v[96:111], a[0:3], v[192:195], v[96:111]
    s_waitcnt lgkmcnt(3)
    s_mov_b32 s69, 315392
    buffer_load_dwordx4 a[160:163], v4, s[32:35], s69 offen offset:2048 sc1
    v_add_f32 v112, v112, v128
    v_add_f32 v113, v113, v129
    v_add_f32 v114, v114, v130
    v_mfma_f32_32x32x16_bf16 v[64:79], a[20:23], v[196:199], v[64:79]
    ds_read_b128 v[212:215], v3 offset:19264
    v_add_f32 v115, v115, v131
    v_add_f32 v116, v116, v132
    v_add_f32 v117, v117, v133
    v_add_f32 v118, v118, v134
    v_mfma_f32_32x32x16_bf16 v[80:95], a[16:19], v[196:199], v[80:95]
    v_add_f32 v119, v119, v135
    v_add_f32 v120, v120, v136
    v_add_f32 v121, v121, v137
    v_add_f32 v122, v122, v138
    v_add_f32 v123, v123, v139
    v_mfma_f32_32x32x16_bf16 v[96:111], a[12:15], v[196:199], v[96:111]
    s_waitcnt lgkmcnt(3)
    buffer_load_dwordx4 a[156:159], v4, s[32:35], s69 offen offset:1024 sc1
    v_add_f32 v124, v124, v140
    v_add_f32 v125, v125, v141
    v_add_f32 v126, v126, v142
    v_add_f32 v127, v127, v143
    v_mfma_f32_32x32x16_bf16 v[64:79], a[32:35], v[200:203], v[64:79]
    ds_read_b128 v[192:195], v3 offset:27936
    v_mfma_f32_32x32x16_bf16 v[80:95], a[28:31], v[200:203], v[80:95]
    v_mfma_f32_32x32x16_bf16 v[96:111], a[24:27], v[200:203], v[96:111]
    s_waitcnt lgkmcnt(3)
    buffer_load_dwordx4 a[164:167], v4, s[32:35], s69 offen offset:3072 sc1
    v_mfma_f32_32x32x16_bf16 v[64:79], a[44:47], v[204:207], v[64:79]
    ds_read_b128 v[196:199], v3 offset:28208
    v_mfma_f32_32x32x16_bf16 v[80:95], a[40:43], v[204:207], v[80:95]
    v_mfma_f32_32x32x16_bf16 v[96:111], a[36:39], v[204:207], v[96:111]
    s_waitcnt lgkmcnt(3)
    v_mfma_f32_32x32x16_bf16 v[64:79], a[56:59], v[208:211], v[64:79]
    ds_read_b128 v[200:203], v3 offset:28480
    s_mov_b32 s69, 323584
    buffer_load_dwordx4 a[196:199], v4, s[32:35], s69 offen offset:3072 sc1
    v_mfma_f32_32x32x16_bf16 v[80:95], a[52:55], v[208:211], v[80:95]
    v_mfma_f32_32x32x16_bf16 v[96:111], a[48:51], v[208:211], v[96:111]
    s_waitcnt vmcnt(10) lgkmcnt(3)
    v_mfma_f32_32x32x16_bf16 v[64:79], a[68:71], v[212:215], v[64:79]
    ds_read_b128 v[204:207], v3 offset:27968
    buffer_load_dwordx4 a[192:195], v4, s[32:35], s69 offen offset:2048 sc1
    v_mfma_f32_32x32x16_bf16 v[80:95], a[64:67], v[212:215], v[80:95]
    v_mfma_f32_32x32x16_bf16 v[96:111], a[60:63], v[212:215], v[96:111]
    s_waitcnt lgkmcnt(3)
    v_mfma_f32_32x32x16_bf16 v[80:95], a[8:11], v[192:195], v[80:95]
    ds_read_b128 v[208:211], v3 offset:28240
    s_mov_b32 s69, 327680
    buffer_load_dwordx4 a[200:203], v4, s[32:35], s69 offen offset:0 sc1
    s_nop 2
    v_add_f32 v56, v56, v64
    v_fmac_f32 v58, v64, v64
    v_mfma_f32_32x32x16_bf16 v[96:111], a[4:7], v[192:195], v[96:111]
    v_add_f32 v57, v57, v65
    v_fmac_f32 v59, v65, v65
    v_add_f32 v56, v56, v66
    v_fmac_f32 v58, v66, v66
    v_add_f32 v57, v57, v67
    v_mfma_f32_32x32x16_bf16 v[112:127], a[0:3], v[192:195], v[112:127]
    s_waitcnt lgkmcnt(3)
    v_fmac_f32 v59, v67, v67
    v_add_f32 v56, v56, v68
    v_fmac_f32 v58, v68, v68
    v_add_f32 v57, v57, v69
    v_fmac_f32 v59, v69, v69
    v_mfma_f32_32x32x16_bf16 v[80:95], a[20:23], v[196:199], v[80:95]
    ds_read_b128 v[212:215], v3 offset:28512
    v_add_f32 v56, v56, v70
    v_fmac_f32 v58, v70, v70
    v_add_f32 v57, v57, v71
    v_fmac_f32 v59, v71, v71
    v_mfma_f32_32x32x16_bf16 v[96:111], a[16:19], v[196:199], v[96:111]
    s_mov_b32 s69, 294912
    buffer_load_dwordx4 a[80:83], v4, s[32:35], s69 offen offset:2048 sc1
    v_add_f32 v56, v56, v72
    v_fmac_f32 v58, v72, v72
    v_add_f32 v57, v57, v73
    v_mfma_f32_32x32x16_bf16 v[112:127], a[12:15], v[196:199], v[112:127]
    s_waitcnt lgkmcnt(3)
    v_fmac_f32 v59, v73, v73
    v_add_f32 v56, v56, v74
    v_fmac_f32 v58, v74, v74
    v_add_f32 v57, v57, v75
    v_fmac_f32 v59, v75, v75
    v_mfma_f32_32x32x16_bf16 v[80:95], a[32:35], v[200:203], v[80:95]
    ds_read_b128 v[192:195], v3 offset:37184
    v_add_f32 v56, v56, v76
    v_fmac_f32 v58, v76, v76
    v_add_f32 v57, v57, v77
    v_fmac_f32 v59, v77, v77
    v_mfma_f32_32x32x16_bf16 v[96:111], a[28:31], v[200:203], v[96:111]
    buffer_load_dwordx4 a[76:79], v4, s[32:35], s69 offen offset:1024 sc1
    v_add_f32 v56, v56, v78
    v_fmac_f32 v58, v78, v78
    v_add_f32 v57, v57, v79
    v_fmac_f32 v59, v79, v79
    v_mfma_f32_32x32x16_bf16 v[112:127], a[24:27], v[200:203], v[112:127]
    s_waitcnt lgkmcnt(3)
    v_cvt_pk_bf16_f32 v216, v64, v65
    v_cvt_pk_bf16_f32 v217, v66, v67
    v_cvt_pk_bf16_f32 v218, v68, v69
    v_cvt_pk_bf16_f32 v219, v70, v71
    v_cvt_pk_bf16_f32 v220, v72, v73
    v_mfma_f32_32x32x16_bf16 v[80:95], a[44:47], v[204:207], v[80:95]
    ds_read_b128 v[196:199], v3 offset:37456
    buffer_store_dwordx4 v[216:219], v2, s[32:35], s72 offen sc1
    v_cvt_pk_bf16_f32 v221, v74, v75
    v_cvt_pk_bf16_f32 v222, v76, v77
    v_cvt_pk_bf16_f32 v223, v78, v79
    v_mfma_f32_32x32x16_bf16 v[96:111], a[40:43], v[204:207], v[96:111]
    buffer_load_dwordx4 a[72:75], v4, s[32:35], s69 offen offset:0 sc1
    buffer_store_dwordx4 v[220:223], v2, s[32:35], s72 offen offset:1024 sc1
    v_mfma_f32_32x32x16_bf16 v[112:127], a[36:39], v[204:207], v[112:127]
    s_waitcnt lgkmcnt(3)
    v_mfma_f32_32x32x16_bf16 v[80:95], a[56:59], v[208:211], v[80:95]
    ds_read_b128 v[200:203], v3 offset:37728
    v_mfma_f32_32x32x16_bf16 v[96:111], a[52:55], v[208:211], v[96:111]
    v_mfma_f32_32x32x16_bf16 v[112:127], a[48:51], v[208:211], v[112:127]
    s_waitcnt lgkmcnt(3)
    v_mfma_f32_32x32x16_bf16 v[80:95], a[68:71], v[212:215], v[80:95]
    ds_read_b128 v[204:207], v3 offset:37216
    v_mfma_f32_32x32x16_bf16 v[96:111], a[64:67], v[212:215], v[96:111]
    v_mfma_f32_32x32x16_bf16 v[112:127], a[60:63], v[212:215], v[112:127]
    s_waitcnt lgkmcnt(3)
    v_mfma_f32_32x32x16_bf16 v[96:111], a[8:11], v[192:195], v[96:111]
    ds_read_b128 v[208:211], v3 offset:37488
    s_mov_b32 s69, 299008
    buffer_load_dwordx4 a[96:99], v4, s[32:35], s69 offen offset:2048 sc1
    s_nop 3
    v_add_f32 v56, v56, v80
    v_fmac_f32 v58, v80, v80
    v_mfma_f32_32x32x16_bf16 v[112:127], a[4:7], v[192:195], v[112:127]
    s_waitcnt lgkmcnt(3)
    v_add_f32 v57, v57, v81
    v_fmac_f32 v59, v81, v81
    v_add_f32 v56, v56, v82
    v_fmac_f32 v58, v82, v82
    v_add_f32 v57, v57, v83
    v_mfma_f32_32x32x16_bf16 v[96:111], a[20:23], v[196:199], v[96:111]
    ds_read_b128 v[212:215], v3 offset:37760
    v_fmac_f32 v59, v83, v83
    v_add_f32 v56, v56, v84
    v_fmac_f32 v58, v84, v84
    v_add_f32 v57, v57, v85
    v_mfma_f32_32x32x16_bf16 v[112:127], a[16:19], v[196:199], v[112:127]
    s_waitcnt lgkmcnt(3)
    buffer_load_dwordx4 a[100:103], v4, s[32:35], s69 offen offset:3072 sc1
    v_fmac_f32 v59, v85, v85
    v_add_f32 v56, v56, v86
    v_fmac_f32 v58, v86, v86
    v_add_f32 v57, v57, v87
    v_mfma_f32_32x32x16_bf16 v[96:111], a[32:35], v[200:203], v[96:111]
    ds_read_b128 v[192:195], v3 offset:46432
    v_fmac_f32 v59, v87, v87
    v_add_f32 v56, v56, v88
    v_fmac_f32 v58, v88, v88
    v_add_f32 v57, v57, v89
    v_mfma_f32_32x32x16_bf16 v[112:127], a[28:31], v[200:203], v[112:127]
    s_waitcnt lgkmcnt(3)
    v_fmac_f32 v59, v89, v89
    v_add_f32 v56, v56, v90
    v_fmac_f32 v58, v90, v90
    v_add_f32 v57, v57, v91
    v_fmac_f32 v59, v91, v91
    v_mfma_f32_32x32x16_bf16 v[96:111], a[44:47], v[204:207], v[96:111]
    ds_read_b128 v[196:199], v3 offset:46704
    s_mov_b32 s69, 303104
    buffer_load_dwordx4 a[104:107], v4, s[32:35], s69 offen offset:0 sc1
    v_add_f32 v56, v56, v92
    v_fmac_f32 v58, v92, v92
    v_mfma_f32_32x32x16_bf16 v[112:127], a[40:43], v[204:207], v[112:127]
    s_waitcnt lgkmcnt(3)
    v_add_f32 v57, v57, v93
    v_fmac_f32 v59, v93, v93
    v_add_f32 v56, v56, v94
    v_fmac_f32 v58, v94, v94
    v_add_f32 v57, v57, v95
    v_mfma_f32_32x32x16_bf16 v[96:111], a[56:59], v[208:211], v[96:111]
    ds_read_b128 v[200:203], v3 offset:46976
    v_fmac_f32 v59, v95, v95
    v_cvt_pk_bf16_f32 v224, v80, v81
    v_cvt_pk_bf16_f32 v225, v82, v83
    v_cvt_pk_bf16_f32 v226, v84, v85
    v_mfma_f32_32x32x16_bf16 v[112:127], a[52:55], v[208:211], v[112:127]
    s_waitcnt lgkmcnt(3)
    v_cvt_pk_bf16_f32 v227, v86, v87
    v_cvt_pk_bf16_f32 v228, v88, v89
    v_cvt_pk_bf16_f32 v229, v90, v91
    v_cvt_pk_bf16_f32 v230, v92, v93
    v_cvt_pk_bf16_f32 v231, v94, v95
    v_mfma_f32_32x32x16_bf16 v[96:111], a[68:71], v[212:215], v[96:111]
    ds_read_b128 v[204:207], v3 offset:46464
    buffer_store_dwordx4 v[224:227], v5, s[32:35], s73 offen sc1
    buffer_store_dwordx4 v[228:231], v5, s[32:35], s73 offen offset:1024 sc1
    v_mfma_f32_32x32x16_bf16 v[112:127], a[64:67], v[212:215], v[112:127]
    s_waitcnt lgkmcnt(3)
    v_mfma_f32_32x32x16_bf16 v[112:127], a[8:11], v[192:195], v[112:127]
    s_waitcnt lgkmcnt(2)
    ds_read_b128 v[208:211], v3 offset:46736
    buffer_load_dwordx4 a[116:119], v4, s[32:35], s69 offen offset:3072 sc1
    v_mfma_f32_32x32x16_bf16 v[112:127], a[20:23], v[196:199], v[112:127]
    s_waitcnt lgkmcnt(2)
    ds_read_b128 v[212:215], v3 offset:47008
    v_add_f32 v56, v56, v96
    v_fmac_f32 v58, v96, v96
    v_add_f32 v57, v57, v97
    v_fmac_f32 v59, v97, v97
    v_mfma_f32_32x32x16_bf16 v[112:127], a[32:35], v[200:203], v[112:127]
    s_waitcnt lgkmcnt(2)
    v_add_f32 v56, v56, v98
    v_fmac_f32 v58, v98, v98
    v_add_f32 v57, v57, v99
    v_fmac_f32 v59, v99, v99
    v_add_f32 v56, v56, v100
    v_mfma_f32_32x32x16_bf16 v[112:127], a[44:47], v[204:207], v[112:127]
    s_waitcnt lgkmcnt(1)
    buffer_load_dwordx4 a[112:115], v4, s[32:35], s69 offen offset:2048 sc1
    v_fmac_f32 v58, v100, v100
    v_add_f32 v57, v57, v101
    v_fmac_f32 v59, v101, v101
    v_add_f32 v56, v56, v102
    v_mfma_f32_32x32x16_bf16 v[112:127], a[56:59], v[208:211], v[112:127]
    s_waitcnt lgkmcnt(0)
    v_fmac_f32 v58, v102, v102
    v_add_f32 v57, v57, v103
    v_fmac_f32 v59, v103, v103
    v_add_f32 v56, v56, v104
    v_fmac_f32 v58, v104, v104
    v_mfma_f32_32x32x16_bf16 v[112:127], a[68:71], v[212:215], v[112:127]
    v_add_f32 v57, v57, v105
    v_fmac_f32 v59, v105, v105
    v_add_f32 v56, v56, v106
    v_fmac_f32 v58, v106, v106
    v_add_f32 v57, v57, v107
    v_fmac_f32 v59, v107, v107
    v_add_f32 v56, v56, v108
    v_fmac_f32 v58, v108, v108
    v_add_f32 v57, v57, v109
    v_fmac_f32 v59, v109, v109
    v_add_f32 v56, v56, v110
    v_fmac_f32 v58, v110, v110
    v_add_f32 v57, v57, v111
    v_fmac_f32 v59, v111, v111
    v_pk_add_f32 v[56:57], v[56:57], v[112:113]
    v_pk_fma_f32 v[58:59], v[112:113], v[112:113], v[58:59]
    v_pk_add_f32 v[56:57], v[56:57], v[114:115]
    v_pk_fma_f32 v[58:59], v[114:115], v[114:115], v[58:59]
    v_pk_add_f32 v[56:57], v[56:57], v[116:117]
    v_pk_fma_f32 v[58:59], v[116:117], v[116:117], v[58:59]
    v_pk_add_f32 v[56:57], v[56:57], v[118:119]
    v_pk_fma_f32 v[58:59], v[118:119], v[118:119], v[58:59]
    v_pk_add_f32 v[56:57], v[56:57], v[120:121]
    v_pk_fma_f32 v[58:59], v[120:121], v[120:121], v[58:59]
    v_pk_add_f32 v[56:57], v[56:57], v[122:123]
    v_pk_fma_f32 v[58:59], v[122:123], v[122:123], v[58:59]
    v_pk_add_f32 v[56:57], v[56:57], v[124:125]
    v_pk_fma_f32 v[58:59], v[124:125], v[124:125], v[58:59]
    v_pk_add_f32 v[56:57], v[56:57], v[126:127]
    v_pk_fma_f32 v[58:59], v[126:127], v[126:127], v[58:59]
    v_add_f32 v56, v56, v57
    v_add_f32 v57, v58, v59
    s_nop 0
    v_add_f32_dpp v56, v56, v56 row_shr:1 row_mask:0xf bank_mask:0xf
    v_add_f32_dpp v57, v57, v57 row_shr:1 row_mask:0xf bank_mask:0xf
    s_nop 0
    v_add_f32_dpp v56, v56, v56 row_shr:2 row_mask:0xf bank_mask:0xf
    v_add_f32_dpp v57, v57, v57 row_shr:2 row_mask:0xf bank_mask:0xf
    s_nop 0
    v_add_f32_dpp v56, v56, v56 row_shr:4 row_mask:0xf bank_mask:0xf
    v_add_f32_dpp v57, v57, v57 row_shr:4 row_mask:0xf bank_mask:0xf
    s_nop 0
    v_add_f32_dpp v56, v56, v56 row_shr:8 row_mask:0xf bank_mask:0xf
    v_add_f32_dpp v57, v57, v57 row_shr:8 row_mask:0xf bank_mask:0xf
    s_nop 0
    v_add_f32_dpp v56, v56, v56 row_bcast:15 row_mask:0xa bank_mask:0xf
    v_add_f32_dpp v57, v57, v57 row_bcast:15 row_mask:0xa bank_mask:0xf
    s_nop 0
    v_add_f32_dpp v56, v56, v56 row_bcast:31 row_mask:0xc bank_mask:0xf
    v_add_f32_dpp v57, v57, v57 row_bcast:31 row_mask:0xc bank_mask:0xf
    s_mov_b32 exec_lo, 0
    s_mov_b32 exec_hi, 0x80000000
    buffer_store_dwordx2 v[56:57], off, s[32:35], s80 sc1
    buffer_store_dwordx2 v[56:57], off, s[32:35], s80 offset:1024 sc1
    s_mov_b64 exec, -1
    v_cvt_pk_bf16_f32 v216, v112, v113
    v_cvt_pk_bf16_f32 v217, v114, v115
    v_cvt_pk_bf16_f32 v218, v116, v117
    v_cvt_pk_bf16_f32 v219, v118, v119
    v_cvt_pk_bf16_f32 v220, v120, v121
    v_cvt_pk_bf16_f32 v221, v122, v123
    v_cvt_pk_bf16_f32 v222, v124, v125
    v_cvt_pk_bf16_f32 v223, v126, v127
    buffer_store_dwordx4 v[216:219], v2, s[32:35], s75 offen sc1
    buffer_store_dwordx4 v[220:223], v2, s[32:35], s75 offen offset:1024 sc1
    v_cvt_pk_bf16_f32 v224, v96, v97
    v_cvt_pk_bf16_f32 v225, v98, v99
    v_cvt_pk_bf16_f32 v226, v100, v101
    v_cvt_pk_bf16_f32 v227, v102, v103
    v_cvt_pk_bf16_f32 v228, v104, v105
    v_cvt_pk_bf16_f32 v229, v106, v107
    v_cvt_pk_bf16_f32 v230, v108, v109
    v_cvt_pk_bf16_f32 v231, v110, v111
    buffer_store_dwordx4 v[224:227], v5, s[32:35], s74 offen sc1
    buffer_store_dwordx4 v[228:231], v5, s[32:35], s74 offen offset:1024 sc1
    s_mov_b32 s50, 0xbfb8aa3b
    v_lshlrev_b32 v24, 16, v176
    v_and_b32 v25, s47, v176
    v_lshlrev_b32 v26, 16, v177
    v_and_b32 v27, s47, v177
    v_lshlrev_b32 v28, 16, v178
    v_and_b32 v29, s47, v178
    v_lshlrev_b32 v30, 16, v179
    v_and_b32 v31, s47, v179
    v_lshlrev_b32 v32, 16, v180
    v_and_b32 v33, s47, v180
    v_lshlrev_b32 v34, 16, v181
    v_and_b32 v35, s47, v181
    v_lshlrev_b32 v36, 16, v182
    v_and_b32 v37, s47, v182
    v_lshlrev_b32 v38, 16, v183
    v_and_b32 v39, s47, v183
    v_lshlrev_b32 v40, 16, v184
    v_and_b32 v41, s47, v184
    v_lshlrev_b32 v42, 16, v185
    v_and_b32 v43, s47, v185
    v_lshlrev_b32 v44, 16, v186
    v_and_b32 v45, s47, v186
    v_lshlrev_b32 v46, 16, v187
    v_and_b32 v47, s47, v187
    v_lshlrev_b32 v48, 16, v188
    v_and_b32 v49, s47, v188
    v_lshlrev_b32 v50, 16, v189
    v_and_b32 v51, s47, v189
    v_lshlrev_b32 v52, 16, v190
    v_and_b32 v53, s47, v190
    v_lshlrev_b32 v54, 16, v191
    v_and_b32 v55, s47, v191
    v_mul_f32 v40, s50, v40
    v_mul_f32 v41, s50, v41
    v_mul_f32 v42, s50, v42
    v_mul_f32 v43, s50, v43
    v_mul_f32 v44, s50, v44
    v_mul_f32 v45, s50, v45
    v_mul_f32 v46, s50, v46
    v_mul_f32 v47, s50, v47
    v_mul_f32 v48, s50, v48
    v_mul_f32 v49, s50, v49
    v_mul_f32 v50, s50, v50
    v_mul_f32 v51, s50, v51
    v_mul_f32 v52, s50, v52
    v_mul_f32 v53, s50, v53
    v_mul_f32 v54, s50, v54
    v_mul_f32 v55, s50, v55
    s_mov_b32 s58, 0xbfb8aa3b
    s_mov_b32 s59, 0xbfb8aa3b
    ds_read_b64 v[192:193], v18 offset:12288
    ds_read_b64 v[194:195], v18 offset:12304
    ds_read_b64 v[196:197], v18 offset:12320
    ds_read_b64 v[198:199], v18 offset:12336
    ds_read_b64 v[200:201], v18 offset:24576
    ds_read_b64 v[202:203], v18 offset:24592
    ds_read_b64 v[204:205], v18 offset:24608
    ds_read_b64 v[206:207], v18 offset:24624
    s_waitcnt lgkmcnt(7)
    v_lshlrev_b32 v128, 16, v192
    v_and_b32 v129, s47, v192
    v_lshlrev_b32 v130, 16, v193
    v_and_b32 v131, s47, v193
    s_waitcnt lgkmcnt(6)
    v_lshlrev_b32 v132, 16, v194
    v_and_b32 v133, s47, v194
    v_lshlrev_b32 v134, 16, v195
    v_and_b32 v135, s47, v195
    s_waitcnt lgkmcnt(5)
    v_lshlrev_b32 v136, 16, v196
    v_and_b32 v137, s47, v196
    v_lshlrev_b32 v138, 16, v197
    v_and_b32 v139, s47, v197
    s_waitcnt lgkmcnt(4)
    v_lshlrev_b32 v140, 16, v198
    v_and_b32 v141, s47, v198
    v_lshlrev_b32 v142, 16, v199
    v_and_b32 v143, s47, v199
    v_pk_mul_f32 v[128:129], v[128:129], s[58:59]
    v_pk_mul_f32 v[130:131], v[130:131], s[58:59]
    v_pk_mul_f32 v[132:133], v[132:133], s[58:59]
    v_pk_mul_f32 v[134:135], v[134:135], s[58:59]
    v_pk_mul_f32 v[136:137], v[136:137], s[58:59]
    v_pk_mul_f32 v[138:139], v[138:139], s[58:59]
    v_pk_mul_f32 v[140:141], v[140:141], s[58:59]
    v_pk_mul_f32 v[142:143], v[142:143], s[58:59]
    s_waitcnt lgkmcnt(3)
    v_lshlrev_b32 v144, 16, v200
    v_and_b32 v145, s47, v200
    v_lshlrev_b32 v146, 16, v201
    v_and_b32 v147, s47, v201
    s_waitcnt lgkmcnt(2)
    v_lshlrev_b32 v148, 16, v202
    v_and_b32 v149, s47, v202
    v_lshlrev_b32 v150, 16, v203
    v_and_b32 v151, s47, v203
    s_waitcnt lgkmcnt(1)
    v_lshlrev_b32 v152, 16, v204
    v_and_b32 v153, s47, v204
    v_lshlrev_b32 v154, 16, v205
    v_and_b32 v155, s47, v205
    s_waitcnt lgkmcnt(0)
    v_lshlrev_b32 v156, 16, v206
    v_and_b32 v157, s47, v206
    v_lshlrev_b32 v158, 16, v207
    v_and_b32 v159, s47, v207
    v_pk_mul_f32 v[144:145], v[144:145], s[58:59]
    v_pk_mul_f32 v[146:147], v[146:147], s[58:59]
    v_pk_mul_f32 v[148:149], v[148:149], s[58:59]
    v_pk_mul_f32 v[150:151], v[150:151], s[58:59]
    v_pk_mul_f32 v[152:153], v[152:153], s[58:59]
    v_pk_mul_f32 v[154:155], v[154:155], s[58:59]
    v_pk_mul_f32 v[156:157], v[156:157], s[58:59]
    v_pk_mul_f32 v[158:159], v[158:159], s[58:59]
    ds_read_b64 v[192:193], v18 offset:36864
    ds_read_b64 v[194:195], v18 offset:36880
    ds_read_b64 v[196:197], v18 offset:36896
    ds_read_b64 v[198:199], v18 offset:36912
    ds_read_b64 v[200:201], v18 offset:49152
    ds_read_b64 v[202:203], v18 offset:49168
    ds_read_b64 v[204:205], v18 offset:49184
    ds_read_b64 v[206:207], v18 offset:49200
    s_waitcnt lgkmcnt(7)
    v_lshlrev_b32 v160, 16, v192
    v_and_b32 v161, s47, v192
    v_lshlrev_b32 v162, 16, v193
    v_and_b32 v163, s47, v193
    s_waitcnt lgkmcnt(6)
    v_lshlrev_b32 v164, 16, v194
    v_and_b32 v165, s47, v194
    v_lshlrev_b32 v166, 16, v195
    v_and_b32 v167, s47, v195
    s_waitcnt lgkmcnt(5)
    v_lshlrev_b32 v168, 16, v196
    v_and_b32 v169, s47, v196
    v_lshlrev_b32 v170, 16, v197
    v_and_b32 v171, s47, v197
    s_waitcnt lgkmcnt(4)
    v_lshlrev_b32 v172, 16, v198
    v_and_b32 v173, s47, v198
    v_lshlrev_b32 v174, 16, v199
    v_and_b32 v175, s47, v199
    v_pk_mul_f32 v[160:161], v[160:161], s[58:59]
    v_pk_mul_f32 v[162:163], v[162:163], s[58:59]
    v_pk_mul_f32 v[164:165], v[164:165], s[58:59]
    v_pk_mul_f32 v[166:167], v[166:167], s[58:59]
    v_pk_mul_f32 v[168:169], v[168:169], s[58:59]
    v_pk_mul_f32 v[170:171], v[170:171], s[58:59]
    v_pk_mul_f32 v[172:173], v[172:173], s[58:59]
    v_pk_mul_f32 v[174:175], v[174:175], s[58:59]
    s_waitcnt lgkmcnt(3)
    v_lshlrev_b32 v176, 16, v200
    v_and_b32 v177, s47, v200
    v_lshlrev_b32 v178, 16, v201
    v_and_b32 v179, s47, v201
    s_waitcnt lgkmcnt(2)
    v_lshlrev_b32 v180, 16, v202
    v_and_b32 v181, s47, v202
    v_lshlrev_b32 v182, 16, v203
    v_and_b32 v183, s47, v203
    s_waitcnt lgkmcnt(1)
    v_lshlrev_b32 v184, 16, v204
    v_and_b32 v185, s47, v204
    v_lshlrev_b32 v186, 16, v205
    v_and_b32 v187, s47, v205
    s_waitcnt lgkmcnt(0)
    v_lshlrev_b32 v188, 16, v206
    v_and_b32 v189, s47, v206
    v_lshlrev_b32 v190, 16, v207
    v_and_b32 v191, s47, v207
    v_pk_mul_f32 v[176:177], v[176:177], s[58:59]
    v_pk_mul_f32 v[178:179], v[178:179], s[58:59]
    v_pk_mul_f32 v[180:181], v[180:181], s[58:59]
    v_pk_mul_f32 v[182:183], v[182:183], s[58:59]
    v_pk_mul_f32 v[184:185], v[184:185], s[58:59]
    v_pk_mul_f32 v[186:187], v[186:187], s[58:59]
    v_pk_mul_f32 v[188:189], v[188:189], s[58:59]
    v_pk_mul_f32 v[190:191], v[190:191], s[58:59]
    buffer_load_dwordx4 v[216:219], v2, s[32:35], s81 offen sc1
    s_mov_b32 s70, 0
    s_sleep 4
L_w2loop:
    buffer_load_dwordx4 v[220:223], v2, s[32:35], s81 offen sc1
    s_waitcnt vmcnt(1)
    v_max3_u32 v59, v216, v217, v218
    v_max_u32 v59, v59, v219
    v_cmp_eq_u32 vcc, -1, v59
    s_add_u32 s70, s70, 1
    s_cbranch_vccz L_w2doneA
    s_cmp_ge_u32 s70, 20000
    s_cbranch_scc1 L_w2doneA
    s_sleep 2
    buffer_load_dwordx4 v[216:219], v2, s[32:35], s81 offen sc1
    s_waitcnt vmcnt(1)
    v_max3_u32 v59, v220, v221, v222
    v_max_u32 v59, v59, v223
    v_cmp_eq_u32 vcc, -1, v59
    s_nop 0
    s_cbranch_vccz L_w2doneB
    s_sleep 2
    s_branch L_w2loop
L_w2doneB:
    v_add_f32 v60, v220, v222
    v_add_f32 v61, v221, v223
    s_branch L_w2sum
L_w2doneA:
    v_add_f32 v60, v216, v218
    v_add_f32 v61, v217, v219
L_w2sum:
    buffer_load_dwordx4 v[232:235], v2, s[32:35], s76 offen offset:0 sc1
    buffer_load_dwordx4 v[240:243], v2, s[32:35], s77 offen offset:0 sc1
    buffer_load_dwordx4 v[248:251], v16, s[32:35], s78 offen offset:0 sc1
    buffer_load_dwordx4 v[236:239], v2, s[32:35], s76 offen offset:1024 sc1
    buffer_load_dwordx4 v[244:247], v2, s[32:35], s77 offen offset:1024 sc1
    buffer_load_dwordx4 v[252:255], v16, s[32:35], s78 offen offset:1024 sc1
    s_mov_b32 s87, 1
    v_add_f32_dpp v60, v60, v60 row_shr:1 row_mask:0xf bank_mask:0xf
    v_add_f32_dpp v61, v61, v61 row_shr:1 row_mask:0xf bank_mask:0xf
    s_nop 0
    v_add_f32_dpp v60, v60, v60 row_shr:2 row_mask:0xf bank_mask:0xf
    v_add_f32_dpp v61, v61, v61 row_shr:2 row_mask:0xf bank_mask:0xf
    s_nop 0
    v_add_f32_dpp v60, v60, v60 row_shr:4 row_mask:0xf bank_mask:0xf
    v_add_f32_dpp v61, v61, v61 row_shr:4 row_mask:0xf bank_mask:0xf
    s_nop 0
    v_add_f32_dpp v60, v60, v60 row_shr:8 row_mask:0xf bank_mask:0xf
    v_add_f32_dpp v61, v61, v61 row_shr:8 row_mask:0xf bank_mask:0xf
    s_nop 0
    v_add_f32_dpp v60, v60, v60 row_bcast:15 row_mask:0xa bank_mask:0xf
    v_add_f32_dpp v61, v61, v61 row_bcast:15 row_mask:0xa bank_mask:0xf
    s_nop 0
    v_add_f32_dpp v60, v60, v60 row_bcast:31 row_mask:0xc bank_mask:0xf
    v_add_f32_dpp v61, v61, v61 row_bcast:31 row_mask:0xc bank_mask:0xf
    v_mul_f32 v60, 0x36000000, v60
    v_mul_f32 v61, 0x36000000, v61
    v_fma_f32 v61, -v60, v60, v61
    v_max_f32 v61, 0, v61
    v_mov_b32 v62, 0x3727c5ac
    v_fmac_f32 v62, 0x3ef5fdf0, v61
    v_rsq_f32 v62, v62
    v_readlane_b32 s96, v60, 63
    v_readlane_b32 s97, v62, 63
    s_nop 1
    v_mul_f32 v24, s97, v24
    v_mul_f32 v25, s97, v25
    v_mul_f32 v26, s97, v26
    v_mul_f32 v27, s97, v27
    v_fma_f32 v40, -v24, s96, v40
    v_fma_f32 v41, -v25, s96, v41
    v_fma_f32 v42, -v26, s96, v42
    v_fma_f32 v43, -v27, s96, v43
    v_fma_f32 v64, v64, v24, v40
    v_fma_f32 v65, v65, v25, v41
    v_fma_f32 v66, v66, v26, v42
    v_fma_f32 v67, v67, v27, v43
    v_fma_f32 v80, v80, v24, v40
    v_fma_f32 v81, v81, v25, v41
    v_fma_f32 v82, v82, v26, v42
    v_fma_f32 v83, v83, v27, v43
    v_exp_f32 v56, v64
    v_exp_f32 v57, v65
    v_exp_f32 v58, v66
    v_exp_f32 v59, v67
    v_exp_f32 v60, v80
    v_exp_f32 v61, v81
    v_exp_f32 v62, v82
    v_exp_f32 v63, v83
    v_add_f32 v56, 1.0, v56
    v_add_f32 v57, 1.0, v57
    v_add_f32 v58, 1.0, v58
    v_add_f32 v59, 1.0, v59
    v_add_f32 v60, 1.0, v60
    v_add_f32 v61, 1.0, v61
    v_add_f32 v62, 1.0, v62
    v_add_f32 v63, 1.0, v63
    v_rcp_f32 v56, v56
    v_rcp_f32 v57, v57
    v_rcp_f32 v58, v58
    v_rcp_f32 v59, v59
    v_rcp_f32 v60, v60
    v_rcp_f32 v61, v61
    v_rcp_f32 v62, v62
    v_rcp_f32 v63, v63
    v_mul_f32 v64, v64, v56
    v_mul_f32 v65, v65, v57
    v_mul_f32 v66, v66, v58
    v_mul_f32 v67, v67, v59
    v_mul_f32 v80, v80, v60
    v_mul_f32 v81, v81, v61
    v_mul_f32 v82, v82, v62
    v_mul_f32 v83, v83, v63
    v_cvt_pk_bf16_f32 v56, v64, v65
    v_cvt_pk_bf16_f32 v57, v66, v67
    ds_write_b64 v12, v[56:57] offset:9248
    v_cvt_pk_bf16_f32 v60, v80, v81
    v_cvt_pk_bf16_f32 v61, v82, v83
    ds_write_b64 v12, v[60:61] offset:18496
    v_fma_f32 v96, v96, v24, v40
    v_fma_f32 v97, v97, v25, v41
    v_fma_f32 v98, v98, v26, v42
    v_fma_f32 v99, v99, v27, v43
    v_fma_f32 v112, v112, v24, v40
    v_fma_f32 v113, v113, v25, v41
    v_fma_f32 v114, v114, v26, v42
    v_fma_f32 v115, v115, v27, v43
    v_exp_f32 v56, v96
    v_exp_f32 v57, v97
    v_exp_f32 v58, v98
    v_exp_f32 v59, v99
    v_exp_f32 v60, v112
    v_exp_f32 v61, v113
    v_exp_f32 v62, v114
    v_exp_f32 v63, v115
    v_add_f32 v56, 1.0, v56
    v_add_f32 v57, 1.0, v57
    v_add_f32 v58, 1.0, v58
    v_add_f32 v59, 1.0, v59
    v_add_f32 v60, 1.0, v60
    v_add_f32 v61, 1.0, v61
    v_add_f32 v62, 1.0, v62
    v_add_f32 v63, 1.0, v63
    v_rcp_f32 v56, v56
    v_rcp_f32 v57, v57
    v_rcp_f32 v58, v58
    v_rcp_f32 v59, v59
    v_rcp_f32 v60, v60
    v_rcp_f32 v61, v61
    v_rcp_f32 v62, v62
    v_rcp_f32 v63, v63
    v_mul_f32 v96, v96, v56
    v_mul_f32 v97, v97, v57
    v_mul_f32 v98, v98, v58
    v_mul_f32 v99, v99, v59
    v_mul_f32 v112, v112, v60
    v_mul_f32 v113, v113, v61
    v_mul_f32 v114, v114, v62
    v_mul_f32 v115, v115, v63
    v_cvt_pk_bf16_f32 v56, v96, v97
    v_cvt_pk_bf16_f32 v57, v98, v99
    ds_write_b64 v12, v[56:57] offset:27744
    v_cvt_pk_bf16_f32 v60, v112, v113
    v_cvt_pk_bf16_f32 v61, v114, v115
    ds_write_b64 v12, v[60:61] offset:36992
    s_waitcnt lgkmcnt(0)
    s_barrier
    ds_read_b128 v[192:195], v3 offset:9520
    ds_read_b128 v[196:199], v3 offset:18768
    ds_read_b128 v[200:203], v3 offset:28016
    ds_read_b128 v[204:207], v3 offset:37264
    s_waitcnt lgkmcnt(3)
    v_mfma_f32_32x32x16_bf16 v[128:143], v[192:195], a[88:91], v[128:143]
    ds_read_b128 v[208:211], v3 offset:9552
    buffer_load_dwordx4 a[108:111], v4, s[32:35], s69 offen offset:1024 sc1
    v_mul_f32 v28, s97, v28
    v_mul_f32 v29, s97, v29
    v_mul_f32 v30, s97, v30
    v_mfma_f32_32x32x16_bf16 v[144:159], v[192:195], a[84:87], v[144:159]
    s_waitcnt lgkmcnt(3)
    v_mul_f32 v31, s97, v31
    v_fma_f32 v44, -v28, s96, v44
    v_fma_f32 v45, -v29, s96, v45
    v_fma_f32 v46, -v30, s96, v46
    v_fma_f32 v47, -v31, s96, v47
    v_mfma_f32_32x32x16_bf16 v[128:143], v[196:199], a[92:95], v[128:143]
    ds_read_b128 v[212:215], v3 offset:18800
    v_fma_f32 v68, v68, v28, v44
    v_fma_f32 v69, v69, v29, v45
    v_fma_f32 v70, v70, v30, v46
    v_fma_f32 v71, v71, v31, v47
    v_mfma_f32_32x32x16_bf16 v[144:159], v[196:199], a[88:91], v[144:159]
    v_exp_f32 v60, v68
    v_exp_f32 v61, v69
    v_add_f32 v60, 1.0, v60
    v_mfma_f32_32x32x16_bf16 v[160:175], v[196:199], a[84:87], v[160:175]
    s_waitcnt lgkmcnt(3)
    v_exp_f32 v62, v70
    v_exp_f32 v63, v71
    v_add_f32 v61, 1.0, v61
    v_mfma_f32_32x32x16_bf16 v[144:159], v[200:203], a[92:95], v[144:159]
    ds_read_b128 v[192:195], v3 offset:28048
    v_add_f32 v62, 1.0, v62
    v_add_f32 v63, 1.0, v63
    v_rcp_f32 v60, v60
    v_mfma_f32_32x32x16_bf16 v[160:175], v[200:203], a[88:91], v[160:175]
    v_rcp_f32 v61, v61
    v_rcp_f32 v62, v62
    v_mul_f32 v68, v68, v60
    v_mfma_f32_32x32x16_bf16 v[176:191], v[200:203], a[84:87], v[176:191]
    s_waitcnt lgkmcnt(3)
    v_rcp_f32 v63, v63
    v_mul_f32 v69, v69, v61
    v_mul_f32 v70, v70, v62
    v_mul_f32 v71, v71, v63
    v_mfma_f32_32x32x16_bf16 v[160:175], v[204:207], a[92:95], v[160:175]
    ds_read_b128 v[196:199], v3 offset:37296
    s_mov_b32 s69, 307200
    buffer_load_dwordx4 a[132:135], v4, s[32:35], s69 offen offset:3072 sc1
    v_cvt_pk_bf16_f32 v60, v68, v69
    v_cvt_pk_bf16_f32 v61, v70, v71
    v_mfma_f32_32x32x16_bf16 v[176:191], v[204:207], a[88:91], v[176:191]
    s_waitcnt lgkmcnt(3)
    ds_write_b64 v12, v[60:61] offset:9312
    v_fma_f32 v84, v84, v28, v44
    v_fma_f32 v85, v85, v29, v45
    v_fma_f32 v86, v86, v30, v46
    v_fma_f32 v87, v87, v31, v47
    v_mfma_f32_32x32x16_bf16 v[128:143], v[208:211], a[124:127], v[128:143]
    v_exp_f32 v56, v84
    v_exp_f32 v57, v85
    v_add_f32 v56, 1.0, v56
    v_mfma_f32_32x32x16_bf16 v[144:159], v[208:211], a[120:123], v[144:159]
    s_waitcnt lgkmcnt(3)
    s_mov_b32 s69, 311296
    buffer_load_dwordx4 a[136:139], v4, s[32:35], s69 offen offset:0 sc1
    v_exp_f32 v58, v86
    v_add_f32 v57, 1.0, v57
    v_mfma_f32_32x32x16_bf16 v[128:143], v[212:215], a[128:131], v[128:143]
    v_exp_f32 v59, v87
    v_add_f32 v58, 1.0, v58
    v_add_f32 v59, 1.0, v59
    v_fma_f32 v100, v100, v28, v44
    v_mfma_f32_32x32x16_bf16 v[144:159], v[212:215], a[124:127], v[144:159]
    v_rcp_f32 v56, v56
    v_rcp_f32 v57, v57
    v_mul_f32 v84, v84, v56
    v_mfma_f32_32x32x16_bf16 v[160:175], v[212:215], a[120:123], v[160:175]
    s_waitcnt lgkmcnt(2)
    buffer_load_dwordx4 a[140:143], v4, s[32:35], s69 offen offset:1024 sc1
    v_rcp_f32 v58, v58
    v_rcp_f32 v59, v59
    v_mfma_f32_32x32x16_bf16 v[144:159], v[192:195], a[128:131], v[144:159]
    v_mul_f32 v85, v85, v57
    v_mul_f32 v86, v86, v58
    v_mul_f32 v87, v87, v59
    v_cvt_pk_bf16_f32 v56, v84, v85
    v_cvt_pk_bf16_f32 v57, v86, v87
    v_mfma_f32_32x32x16_bf16 v[160:175], v[192:195], a[124:127], v[160:175]
    ds_write_b64 v12, v[56:57] offset:18560
    v_fma_f32 v101, v101, v29, v45
    v_fma_f32 v102, v102, v30, v46
    v_fma_f32 v103, v103, v31, v47
    v_fma_f32 v116, v116, v28, v44
    v_mfma_f32_32x32x16_bf16 v[176:191], v[192:195], a[120:123], v[176:191]
    s_waitcnt lgkmcnt(2)
    v_exp_f32 v60, v100
    v_exp_f32 v61, v101
    v_exp_f32 v62, v102
    v_exp_f32 v63, v103
    v_add_f32 v60, 1.0, v60
    v_add_f32 v61, 1.0, v61
    v_add_f32 v62, 1.0, v62
    v_add_f32 v63, 1.0, v63
    v_rcp_f32 v60, v60
    v_rcp_f32 v61, v61
    v_rcp_f32 v62, v62
    v_rcp_f32 v63, v63
    v_mul_f32 v100, v100, v60
    v_mul_f32 v101, v101, v61
    v_mul_f32 v102, v102, v62
    v_mul_f32 v103, v103, v63
    v_cvt_pk_bf16_f32 v60, v100, v101
    v_cvt_pk_bf16_f32 v61, v102, v103
    ds_write_b64 v12, v[60:61] offset:27808
    v_fma_f32 v117, v117, v29, v45
    v_fma_f32 v118, v118, v30, v46
    v_fma_f32 v119, v119, v31, v47
    v_exp_f32 v56, v116
    v_exp_f32 v57, v117
    v_exp_f32 v58, v118
    v_exp_f32 v59, v119
    v_add_f32 v56, 1.0, v56
    v_add_f32 v57, 1.0, v57
    v_add_f32 v58, 1.0, v58
    v_add_f32 v59, 1.0, v59
    v_rcp_f32 v56, v56
    v_rcp_f32 v57, v57
    v_rcp_f32 v58, v58
    v_rcp_f32 v59, v59
    v_mul_f32 v116, v116, v56
    v_mul_f32 v117, v117, v57
    v_mul_f32 v118, v118, v58
    v_mul_f32 v119, v119, v59
    v_cvt_pk_bf16_f32 v56, v116, v117
    v_cvt_pk_bf16_f32 v57, v118, v119
    ds_write_b64 v12, v[56:57] offset:37056
    v_mfma_f32_32x32x16_bf16 v[160:175], v[196:199], a[128:131], v[160:175]
    s_waitcnt lgkmcnt(0)
    s_barrier
    ds_read_b128 v[200:203], v3 offset:9584
    ds_read_b128 v[204:207], v3 offset:18832
    ds_read_b128 v[208:211], v3 offset:28080
    ds_read_b128 v[212:215], v3 offset:37328
    v_mfma_f32_32x32x16_bf16 v[176:191], v[196:199], a[124:127], v[176:191]
    s_waitcnt lgkmcnt(3)
    v_mfma_f32_32x32x16_bf16 v[128:143], v[200:203], a[160:163], v[128:143]
    ds_read_b128 v[192:195], v3 offset:9616
    s_mov_b32 s69, 315392
    buffer_load_dwordx4 a[152:155], v4, s[32:35], s69 offen offset:0 sc1
    v_mfma_f32_32x32x16_bf16 v[144:159], v[200:203], a[156:159], v[144:159]
    s_waitcnt lgkmcnt(3)
    v_mfma_f32_32x32x16_bf16 v[128:143], v[204:207], a[164:167], v[128:143]
    ds_read_b128 v[196:199], v3 offset:18864
    v_mfma_f32_32x32x16_bf16 v[144:159], v[204:207], a[160:163], v[144:159]
    s_mov_b32 s69, 311296
    buffer_load_dwordx4 a[148:151], v4, s[32:35], s69 offen offset:3072 sc1
    v_mfma_f32_32x32x16_bf16 v[160:175], v[204:207], a[156:159], v[160:175]
    s_waitcnt lgkmcnt(3)
    s_waitcnt vmcnt(6)
    v_max3_u32 v59, v232, v233, v234
    v_max3_u32 v59, v59, v235, v236
    v_max3_u32 v59, v59, v237, v238
    v_max3_u32 v59, v59, v239, v240
    v_max3_u32 v59, v59, v241, v242
    v_mfma_f32_32x32x16_bf16 v[144:159], v[208:211], a[164:167], v[144:159]
    ds_read_b128 v[200:203], v3 offset:28112
    v_max3_u32 v59, v59, v243, v244
    v_max3_u32 v59, v59, v245, v246
    v_max3_u32 v59, v59, v247, v248
    v_max3_u32 v59, v59, v249, v250
    v_mfma_f32_32x32x16_bf16 v[160:175], v[208:211], a[160:163], v[160:175]
    buffer_load_dwordx4 a[144:147], v4, s[32:35], s69 offen offset:2048 sc1
    v_max3_u32 v59, v59, v251, v252
    v_max3_u32 v59, v59, v253, v254
    v_max_u32 v59, v59, v255
    v_cmp_eq_u32 vcc, -1, v59
    v_mfma_f32_32x32x16_bf16 v[176:191], v[208:211], a[156:159], v[176:191]
    s_waitcnt lgkmcnt(3)
    s_cbranch_vccnz L_slowH
    L_backH:
    v_lshlrev_b32 v216, 16, v248
    v_and_b32 v217, s47, v248
    v_lshlrev_b32 v218, 16, v249
    v_and_b32 v219, s47, v249
    v_mfma_f32_32x32x16_bf16 v[160:175], v[212:215], a[164:167], v[160:175]
    ds_read_b128 v[204:207], v3 offset:37360
    v_lshlrev_b32 v220, 16, v232
    v_and_b32 v221, s47, v232
    v_lshlrev_b32 v222, 16, v233
    v_and_b32 v223, s47, v233
    v_mfma_f32_32x32x16_bf16 v[176:191], v[212:215], a[160:163], v[176:191]
    s_waitcnt lgkmcnt(3)
    v_lshlrev_b32 v224, 16, v240
    v_and_b32 v225, s47, v240
    v_lshlrev_b32 v226, 16, v241
    v_and_b32 v227, s47, v241
    v_fma_f32 v216, v216, v24, v40
    v_mfma_f32_32x32x16_bf16 v[128:143], v[192:195], a[196:199], v[128:143]
    v_fma_f32 v217, v217, v25, v41
    v_fma_f32 v218, v218, v26, v42
    v_fma_f32 v219, v219, v27, v43
    v_fma_f32 v220, v220, v24, v40
    v_fma_f32 v221, v221, v25, v41
    v_mfma_f32_32x32x16_bf16 v[144:159], v[192:195], a[192:195], v[144:159]
    s_waitcnt lgkmcnt(2)
    v_fma_f32 v222, v222, v26, v42
    v_fma_f32 v223, v223, v27, v43
    v_fma_f32 v224, v224, v24, v40
    v_fma_f32 v225, v225, v25, v41
    v_fma_f32 v226, v226, v26, v42
    v_mfma_f32_32x32x16_bf16 v[128:143], v[196:199], a[200:203], v[128:143]
    v_fma_f32 v227, v227, v27, v43
    v_exp_f32 v228, v216
    v_exp_f32 v229, v217
    v_mfma_f32_32x32x16_bf16 v[144:159], v[196:199], a[196:199], v[144:159]
    v_exp_f32 v230, v218
    v_exp_f32 v231, v219
    v_add_f32 v228, 1.0, v228
    v_mfma_f32_32x32x16_bf16 v[160:175], v[196:199], a[192:195], v[160:175]
    s_waitcnt lgkmcnt(1)
    s_mov_b32 s69, 319488
    buffer_load_dwordx4 a[168:171], v4, s[32:35], s69 offen offset:0 sc1
    v_exp_f32 v56, v220
    v_add_f32 v229, 1.0, v229
    v_mfma_f32_32x32x16_bf16 v[144:159], v[200:203], a[200:203], v[144:159]
    v_exp_f32 v57, v221
    v_exp_f32 v58, v222
    v_add_f32 v230, 1.0, v230
    v_mfma_f32_32x32x16_bf16 v[160:175], v[200:203], a[196:199], v[160:175]
    v_exp_f32 v59, v223
    v_exp_f32 v60, v224
    v_add_f32 v231, 1.0, v231
    v_mfma_f32_32x32x16_bf16 v[176:191], v[200:203], a[192:195], v[176:191]
    s_waitcnt lgkmcnt(0)
    buffer_load_dwordx4 a[172:175], v4, s[32:35], s69 offen offset:1024 sc1
    v_exp_f32 v61, v225
    v_exp_f32 v62, v226
    v_exp_f32 v63, v227
    v_add_f32 v56, 1.0, v56
    v_add_f32 v57, 1.0, v57
    v_add_f32 v58, 1.0, v58
    v_add_f32 v59, 1.0, v59
    v_add_f32 v60, 1.0, v60
    v_add_f32 v61, 1.0, v61
    v_add_f32 v62, 1.0, v62
    v_add_f32 v63, 1.0, v63
    v_rcp_f32 v228, v228
    v_rcp_f32 v229, v229
    v_rcp_f32 v230, v230
    v_rcp_f32 v231, v231
    v_rcp_f32 v56, v56
    v_rcp_f32 v57, v57
    v_rcp_f32 v58, v58
    v_rcp_f32 v59, v59
    v_rcp_f32 v60, v60
    v_rcp_f32 v61, v61
    v_rcp_f32 v62, v62
    v_rcp_f32 v63, v63
    v_mul_f32 v216, v216, v228
    v_mul_f32 v217, v217, v229
    v_mul_f32 v218, v218, v230
    v_mul_f32 v219, v219, v231
    v_mul_f32 v220, v220, v56
    v_mul_f32 v221, v221, v57
    v_mul_f32 v222, v222, v58
    v_mul_f32 v223, v223, v59
    v_mul_f32 v224, v224, v60
    v_mul_f32 v225, v225, v61
    v_mul_f32 v226, v226, v62
    v_mul_f32 v227, v227, v63
    v_cvt_pk_bf16_f32 v228, v216, v217
    v_cvt_pk_bf16_f32 v229, v218, v219
    ds_write_b64 v15, v[228:229] offset:0
    v_cvt_pk_bf16_f32 v56, v220, v221
    v_cvt_pk_bf16_f32 v57, v222, v223
    ds_write_b64 v13, v[56:57] offset:0
    v_cvt_pk_bf16_f32 v60, v224, v225
    v_cvt_pk_bf16_f32 v61, v226, v227
    ds_write_b64 v14, v[60:61] offset:0
    v_mfma_f32_32x32x16_bf16 v[160:175], v[204:207], a[200:203], v[160:175]
    s_waitcnt lgkmcnt(0)
    s_barrier
    ds_read_b128 v[208:211], v3 offset:18496
    ds_read_b128 v[212:215], v3 offset:27744
    ds_read_b128 v[192:195], v3 offset:0
    ds_read_b128 v[196:199], v3 offset:9248
    v_mfma_f32_32x32x16_bf16 v[176:191], v[204:207], a[196:199], v[176:191]
    s_waitcnt lgkmcnt(3)
    v_lshlrev_b32 v216, 16, v234
    v_and_b32 v217, s47, v234
    v_lshlrev_b32 v218, 16, v235
    v_and_b32 v219, s47, v235
    v_fma_f32 v216, v216, v28, v44
    v_mfma_f32_32x32x16_bf16 v[128:143], v[208:211], a[80:83], v[128:143]
    ds_read_b128 v[200:203], v3 offset:36992
    buffer_load_dwordx4 a[176:179], v4, s[32:35], s69 offen offset:2048 sc1
    v_fma_f32 v217, v217, v29, v45
    v_fma_f32 v218, v218, v30, v46
    v_fma_f32 v219, v219, v31, v47
    v_mfma_f32_32x32x16_bf16 v[144:159], v[208:211], a[76:79], v[144:159]
    v_exp_f32 v220, v216
    v_exp_f32 v221, v217
    v_add_f32 v220, 1.0, v220
    v_mfma_f32_32x32x16_bf16 v[160:175], v[208:211], a[72:75], v[160:175]
    s_waitcnt lgkmcnt(3)
    v_exp_f32 v222, v218
    v_exp_f32 v223, v219
    v_add_f32 v221, 1.0, v221
    v_mfma_f32_32x32x16_bf16 v[144:159], v[212:215], a[80:83], v[144:159]
    ds_read_b128 v[204:207], v3 offset:46240
    v_add_f32 v222, 1.0, v222
    v_add_f32 v223, 1.0, v223
    v_rcp_f32 v220, v220
    v_mfma_f32_32x32x16_bf16 v[160:175], v[212:215], a[76:79], v[160:175]
    v_rcp_f32 v221, v221
    v_rcp_f32 v222, v222
    v_mul_f32 v216, v216, v220
    v_mfma_f32_32x32x16_bf16 v[176:191], v[212:215], a[72:75], v[176:191]
    s_waitcnt lgkmcnt(3)
    v_rcp_f32 v223, v223
    v_mul_f32 v217, v217, v221
    v_mul_f32 v218, v218, v222
    v_mul_f32 v219, v219, v223
    v_mfma_f32_32x32x16_bf16 v[128:143], v[192:195], a[72:75], v[128:143]
    s_waitcnt lgkmcnt(2)
    ds_read_b128 v[208:211], v3 offset:272
    s_mov_b32 s69, 323584
    buffer_load_dwordx4 a[188:191], v4, s[32:35], s69 offen offset:1024 sc1
    v_cvt_pk_bf16_f32 v220, v216, v217
    v_cvt_pk_bf16_f32 v221, v218, v219
    v_mfma_f32_32x32x16_bf16 v[144:159], v[196:199], a[72:75], v[144:159]
    ds_read_b128 v[212:215], v3 offset:46512
    ds_write_b64 v13, v[220:221] offset:64
    v_lshlrev_b32 v224, 16, v242
    v_and_b32 v225, s47, v242
    v_lshlrev_b32 v226, 16, v243
    v_mfma_f32_32x32x16_bf16 v[128:143], v[196:199], a[76:79], v[128:143]
    s_waitcnt lgkmcnt(4)
    v_and_b32 v227, s47, v243
    v_fma_f32 v224, v224, v28, v44
    v_fma_f32 v225, v225, v29, v45
    v_fma_f32 v226, v226, v30, v46
    v_fma_f32 v227, v227, v31, v47
    v_mfma_f32_32x32x16_bf16 v[176:191], v[200:203], a[76:79], v[176:191]
    ds_read_b128 v[192:195], v3 offset:544
    buffer_load_dwordx4 a[184:187], v4, s[32:35], s69 offen offset:0 sc1
    v_exp_f32 v228, v224
    v_lshlrev_b32 v216, 16, v250
    v_mfma_f32_32x32x16_bf16 v[160:175], v[200:203], a[80:83], v[160:175]
    s_waitcnt lgkmcnt(4)
    v_exp_f32 v229, v225
    v_exp_f32 v230, v226
    v_add_f32 v228, 1.0, v228
    v_mfma_f32_32x32x16_bf16 v[176:191], v[204:207], a[80:83], v[176:191]
    s_waitcnt lgkmcnt(3)
    ds_read_b128 v[196:199], v3 offset:9792
    v_exp_f32 v231, v227
    v_add_f32 v229, 1.0, v229
    v_add_f32 v230, 1.0, v230
    v_mfma_f32_32x32x16_bf16 v[128:143], v[208:211], a[84:87], v[128:143]
    s_waitcnt lgkmcnt(3)
    ds_read_b128 v[200:203], v3 offset:19040
    s_mov_b32 s69, 319488
    buffer_load_dwordx4 a[180:183], v4, s[32:35], s69 offen offset:3072 sc1
    v_add_f32 v231, 1.0, v231
    v_and_b32 v217, s47, v250
    v_mfma_f32_32x32x16_bf16 v[176:191], v[212:215], a[92:95], v[176:191]
    s_waitcnt lgkmcnt(2)
    ds_read_b128 v[204:207], v3 offset:28288
    v_rcp_f32 v228, v228
    v_rcp_f32 v229, v229
    v_mfma_f32_32x32x16_bf16 v[128:143], v[192:195], a[96:99], v[128:143]
    s_waitcnt lgkmcnt(2)
    ds_read_b128 v[208:211], v3 offset:37536
    v_rcp_f32 v230, v230
    v_rcp_f32 v231, v231
    v_mfma_f32_32x32x16_bf16 v[144:159], v[196:199], a[96:99], v[144:159]
    ds_read_b128 v[212:215], v3 offset:46784
    v_mul_f32 v224, v224, v228
    v_mul_f32 v225, v225, v229
    v_mul_f32 v226, v226, v230
    v_mul_f32 v227, v227, v231
    v_mfma_f32_32x32x16_bf16 v[128:143], v[196:199], a[100:103], v[128:143]
    s_waitcnt lgkmcnt(3)
    v_cvt_pk_bf16_f32 v228, v224, v225
    v_cvt_pk_bf16_f32 v229, v226, v227
    v_lshlrev_b32 v218, 16, v251
    v_and_b32 v219, s47, v251
    v_fma_f32 v216, v216, v28, v44
    v_mfma_f32_32x32x16_bf16 v[144:159], v[200:203], a[100:103], v[144:159]
    ds_read_b128 v[192:195], v3 offset:18528
    ds_write_b64 v14, v[228:229] offset:64
    v_fma_f32 v217, v217, v29, v45
    v_fma_f32 v218, v218, v30, v46
    v_fma_f32 v219, v219, v31, v47
    v_mfma_f32_32x32x16_bf16 v[128:143], v[200:203], a[104:107], v[128:143]
    v_exp_f32 v220, v216
    v_exp_f32 v221, v217
    v_add_f32 v220, 1.0, v220
    v_mfma_f32_32x32x16_bf16 v[160:175], v[200:203], a[96:99], v[160:175]
    s_waitcnt lgkmcnt(4)
    v_exp_f32 v222, v218
    v_exp_f32 v223, v219
    v_add_f32 v221, 1.0, v221
    v_mfma_f32_32x32x16_bf16 v[144:159], v[204:207], a[104:107], v[144:159]
    ds_read_b128 v[196:199], v3 offset:27776
    s_mov_b32 s69, 327680
    buffer_load_dwordx4 a[204:207], v4, s[32:35], s69 offen offset:1024 sc1
    v_add_f32 v222, 1.0, v222
    v_add_f32 v223, 1.0, v223
    v_mfma_f32_32x32x16_bf16 v[176:191], v[204:207], a[96:99], v[176:191]
    v_rcp_f32 v220, v220
    v_rcp_f32 v221, v221
    v_mul_f32 v216, v216, v220
    v_mfma_f32_32x32x16_bf16 v[160:175], v[204:207], a[100:103], v[160:175]
    s_waitcnt lgkmcnt(4)
    v_rcp_f32 v222, v222
    v_rcp_f32 v223, v223
    v_mul_f32 v217, v217, v221
    v_mfma_f32_32x32x16_bf16 v[176:191], v[208:211], a[100:103], v[176:191]
    ds_read_b128 v[200:203], v3 offset:32
    buffer_load_dwordx4 a[208:211], v4, s[32:35], s69 offen offset:2048 sc1
    v_mul_f32 v218, v218, v222
    v_mul_f32 v219, v219, v223
    v_cvt_pk_bf16_f32 v220, v216, v217
    v_mfma_f32_32x32x16_bf16 v[160:175], v[208:211], a[104:107], v[160:175]
    s_waitcnt lgkmcnt(4)
    v_cvt_pk_bf16_f32 v221, v218, v219
    v_mfma_f32_32x32x16_bf16 v[176:191], v[212:215], a[104:107], v[176:191]
    s_waitcnt lgkmcnt(3)
    ds_read_b128 v[204:207], v3 offset:9280
    ds_write_b64 v15, v[220:221] offset:64
    v_mfma_f32_32x32x16_bf16 v[128:143], v[192:195], a[116:119], v[128:143]
    ds_read_b128 v[208:211], v3 offset:37024
    buffer_load_dwordx4 a[212:215], v4, s[32:35], s69 offen offset:3072 sc1
    v_mfma_f32_32x32x16_bf16 v[144:159], v[192:195], a[112:115], v[144:159]
    s_waitcnt vmcnt(15)
    v_mfma_f32_32x32x16_bf16 v[160:175], v[192:195], a[108:111], v[160:175]
    s_waitcnt lgkmcnt(4)
    v_mfma_f32_32x32x16_bf16 v[144:159], v[196:199], a[116:119], v[144:159]
    ds_read_b128 v[212:215], v3 offset:46272
    v_mfma_f32_32x32x16_bf16 v[160:175], v[196:199], a[112:115], v[160:175]
    v_mfma_f32_32x32x16_bf16 v[176:191], v[196:199], a[108:111], v[176:191]
    s_waitcnt lgkmcnt(4)
    v_mfma_f32_32x32x16_bf16 v[128:143], v[200:203], a[108:111], v[128:143]
    s_waitcnt lgkmcnt(3)
    ds_read_b128 v[192:195], v3 offset:304
    s_mov_b32 s69, 331776
    buffer_load_dwordx4 a[0:3], v4, s[32:35], s69 offen offset:0 sc1
    v_mfma_f32_32x32x16_bf16 v[144:159], v[204:207], a[108:111], v[144:159]
    ds_read_b128 v[196:199], v3 offset:46544
    v_mfma_f32_32x32x16_bf16 v[128:143], v[204:207], a[112:115], v[128:143]
    s_waitcnt lgkmcnt(3)
    v_mfma_f32_32x32x16_bf16 v[176:191], v[208:211], a[112:115], v[176:191]
    ds_read_b128 v[200:203], v3 offset:576
    buffer_load_dwordx4 a[4:7], v4, s[32:35], s69 offen offset:1024 sc1
    v_mfma_f32_32x32x16_bf16 v[160:175], v[208:211], a[116:119], v[160:175]
    s_waitcnt lgkmcnt(3)
    v_mfma_f32_32x32x16_bf16 v[176:191], v[212:215], a[116:119], v[176:191]
    s_waitcnt lgkmcnt(2)
    ds_read_b128 v[204:207], v3 offset:9824
    v_mfma_f32_32x32x16_bf16 v[128:143], v[192:195], a[120:123], v[128:143]
    s_waitcnt lgkmcnt(2)
    ds_read_b128 v[208:211], v3 offset:19072
    buffer_load_dwordx4 a[8:11], v4, s[32:35], s69 offen offset:2048 sc1
    v_mfma_f32_32x32x16_bf16 v[176:191], v[196:199], a[128:131], v[176:191]
    s_waitcnt vmcnt(17) lgkmcnt(2)
    ds_read_b128 v[212:215], v3 offset:28320
    v_mfma_f32_32x32x16_bf16 v[128:143], v[200:203], a[132:135], v[128:143]
    s_waitcnt lgkmcnt(2)
    ds_read_b128 v[192:195], v3 offset:37568
    v_mul_f32 v32, s97, v32
    v_mul_f32 v33, s97, v33
    v_mul_f32 v34, s97, v34
    v_mul_f32 v35, s97, v35
    v_mfma_f32_32x32x16_bf16 v[144:159], v[204:207], a[132:135], v[144:159]
    s_waitcnt vmcnt(16)
    ds_read_b128 v[196:199], v3 offset:46816
    v_fma_f32 v48, -v32, s96, v48
    v_fma_f32 v49, -v33, s96, v49
    v_fma_f32 v50, -v34, s96, v50
    v_fma_f32 v51, -v35, s96, v51
    v_mfma_f32_32x32x16_bf16 v[128:143], v[204:207], a[136:139], v[128:143]
    s_waitcnt lgkmcnt(3)
    s_barrier
    v_fma_f32 v72, v72, v32, v48
    v_fma_f32 v73, v73, v33, v49
    v_fma_f32 v74, v74, v34, v50
    v_mfma_f32_32x32x16_bf16 v[144:159], v[208:211], a[136:139], v[144:159]
    s_waitcnt vmcnt(15)
    ds_read_b128 v[200:203], v3 offset:18560
    v_fma_f32 v75, v75, v35, v51
    v_exp_f32 v220, v72
    v_fma_f32 v88, v88, v32, v48
    v_mfma_f32_32x32x16_bf16 v[128:143], v[208:211], a[140:143], v[128:143]
    buffer_load_dwordx4 a[12:15], v4, s[32:35], s69 offen offset:3072 sc1
    v_exp_f32 v221, v73
    v_exp_f32 v222, v74
    v_mfma_f32_32x32x16_bf16 v[160:175], v[208:211], a[132:135], v[160:175]
    s_waitcnt lgkmcnt(3)
    v_exp_f32 v223, v75
    v_add_f32 v220, 1.0, v220
    v_add_f32 v221, 1.0, v221
    v_add_f32 v222, 1.0, v222
    v_mfma_f32_32x32x16_bf16 v[144:159], v[212:215], a[140:143], v[144:159]
    ds_read_b128 v[204:207], v3 offset:27808
    v_add_f32 v223, 1.0, v223
    v_rcp_f32 v220, v220
    v_fma_f32 v89, v89, v33, v49
    v_mfma_f32_32x32x16_bf16 v[176:191], v[212:215], a[132:135], v[176:191]
    s_mov_b32 s69, 335872
    buffer_load_dwordx4 a[16:19], v4, s[32:35], s69 offen offset:0 sc1
    v_rcp_f32 v221, v221
    v_mul_f32 v72, v72, v220
    v_mfma_f32_32x32x16_bf16 v[160:175], v[212:215], a[136:139], v[160:175]
    s_waitcnt lgkmcnt(3)
    v_rcp_f32 v222, v222
    v_rcp_f32 v223, v223
    v_mul_f32 v73, v73, v221
    v_mfma_f32_32x32x16_bf16 v[176:191], v[192:195], a[136:139], v[176:191]
    ds_read_b128 v[208:211], v3 offset:64
    v_mul_f32 v74, v74, v222
    v_mul_f32 v75, v75, v223
    v_cvt_pk_bf16_f32 v220, v72, v73
    v_cvt_pk_bf16_f32 v221, v74, v75
    v_mfma_f32_32x32x16_bf16 v[160:175], v[192:195], a[140:143], v[160:175]
    s_waitcnt lgkmcnt(3)
    buffer_load_dwordx4 a[20:23], v4, s[32:35], s69 offen offset:1024 sc1
    ds_write_b64 v12, v[220:221] offset:9376
    v_fma_f32 v90, v90, v34, v50
    v_fma_f32 v91, v91, v35, v51
    v_fma_f32 v104, v104, v32, v48
    v_mfma_f32_32x32x16_bf16 v[176:191], v[196:199], a[140:143], v[176:191]
    s_waitcnt vmcnt(17) lgkmcnt(3)
    ds_read_b128 v[212:215], v3 offset:9312
    v_exp_f32 v228, v88
    v_exp_f32 v229, v89
    v_mfma_f32_32x32x16_bf16 v[128:143], v[200:203], a[152:155], v[128:143]
    s_waitcnt vmcnt(16)
    ds_read_b128 v[192:195], v3 offset:37056
    v_exp_f32 v230, v90
    v_exp_f32 v231, v91
    v_mfma_f32_32x32x16_bf16 v[144:159], v[200:203], a[148:151], v[144:159]
    s_waitcnt vmcnt(15)
    v_add_f32 v228, 1.0, v228
    v_add_f32 v229, 1.0, v229
    v_add_f32 v230, 1.0, v230
    v_add_f32 v231, 1.0, v231
    v_fma_f32 v105, v105, v33, v49
    v_mfma_f32_32x32x16_bf16 v[160:175], v[200:203], a[144:147], v[160:175]
    s_waitcnt lgkmcnt(4)
    v_rcp_f32 v228, v228
    v_rcp_f32 v229, v229
    v_mul_f32 v88, v88, v228
    v_mfma_f32_32x32x16_bf16 v[144:159], v[204:207], a[152:155], v[144:159]
    ds_read_b128 v[196:199], v3 offset:46304
    v_rcp_f32 v230, v230
    v_rcp_f32 v231, v231
    v_mfma_f32_32x32x16_bf16 v[160:175], v[204:207], a[148:151], v[160:175]
    buffer_load_dwordx4 a[24:27], v4, s[32:35], s69 offen offset:2048 sc1
    v_mul_f32 v89, v89, v229
    v_mul_f32 v90, v90, v230
    v_mul_f32 v91, v91, v231
    v_cvt_pk_bf16_f32 v228, v88, v89
    v_mfma_f32_32x32x16_bf16 v[176:191], v[204:207], a[144:147], v[176:191]
    s_waitcnt lgkmcnt(4)
    v_cvt_pk_bf16_f32 v229, v90, v91
    v_fma_f32 v106, v106, v34, v50
    v_fma_f32 v107, v107, v35, v51
    v_exp_f32 v220, v104
    v_mfma_f32_32x32x16_bf16 v[128:143], v[208:211], a[144:147], v[128:143]
    s_waitcnt lgkmcnt(2)
    ds_read_b128 v[200:203], v3 offset:336
    ds_write_b64 v12, v[228:229] offset:18624
    v_exp_f32 v221, v105
    v_add_f32 v220, 1.0, v220
    v_mfma_f32_32x32x16_bf16 v[144:159], v[212:215], a[144:147], v[144:159]
    ds_read_b128 v[204:207], v3 offset:46576
    buffer_load_dwordx4 a[28:31], v4, s[32:35], s69 offen offset:3072 sc1
    v_exp_f32 v222, v106
    v_add_f32 v221, 1.0, v221
    v_mfma_f32_32x32x16_bf16 v[128:143], v[212:215], a[148:151], v[128:143]
    s_waitcnt lgkmcnt(4)
    v_exp_f32 v223, v107
    v_add_f32 v222, 1.0, v222
    v_add_f32 v223, 1.0, v223
    v_fma_f32 v120, v120, v32, v48
    v_mfma_f32_32x32x16_bf16 v[176:191], v[192:195], a[148:151], v[176:191]
    ds_read_b128 v[208:211], v3 offset:608
    v_rcp_f32 v220, v220
    v_rcp_f32 v221, v221
    v_mfma_f32_32x32x16_bf16 v[160:175], v[192:195], a[152:155], v[160:175]
    s_waitcnt lgkmcnt(4)
    s_mov_b32 s69, 339968
    buffer_load_dwordx4 a[32:35], v4, s[32:35], s69 offen offset:0 sc1
    v_rcp_f32 v222, v222
    v_mul_f32 v104, v104, v220
    v_mfma_f32_32x32x16_bf16 v[176:191], v[196:199], a[152:155], v[176:191]
    s_waitcnt lgkmcnt(3)
    ds_read_b128 v[212:215], v3 offset:9856
    v_rcp_f32 v223, v223
    v_mul_f32 v105, v105, v221
    v_mul_f32 v106, v106, v222
    v_mfma_f32_32x32x16_bf16 v[128:143], v[200:203], a[156:159], v[128:143]
    s_waitcnt lgkmcnt(2)
    ds_read_b128 v[192:195], v3 offset:19104
    v_mul_f32 v107, v107, v223
    v_cvt_pk_bf16_f32 v220, v104, v105
    v_cvt_pk_bf16_f32 v221, v106, v107
    v_fma_f32 v121, v121, v33, v49
    v_mfma_f32_32x32x16_bf16 v[176:191], v[204:207], a[164:167], v[176:191]
    s_waitcnt vmcnt(17) lgkmcnt(2)
    ds_read_b128 v[196:199], v3 offset:28352
    ds_write_b64 v12, v[220:221] offset:27872
    v_fma_f32 v122, v122, v34, v50
    v_fma_f32 v123, v123, v35, v51
    v_lshlrev_b32 v216, 16, v236
    v_mfma_f32_32x32x16_bf16 v[128:143], v[208:211], a[168:171], v[128:143]
    s_waitcnt lgkmcnt(3)
    ds_read_b128 v[200:203], v3 offset:37600
    v_exp_f32 v228, v120
    v_exp_f32 v229, v121
    v_mfma_f32_32x32x16_bf16 v[144:159], v[212:215], a[168:171], v[144:159]
    s_waitcnt vmcnt(16)
    ds_read_b128 v[204:207], v3 offset:46848
    v_exp_f32 v230, v122
    v_exp_f32 v231, v123
    v_mfma_f32_32x32x16_bf16 v[128:143], v[212:215], a[172:175], v[128:143]
    s_waitcnt lgkmcnt(4)
    buffer_load_dwordx4 a[36:39], v4, s[32:35], s69 offen offset:1024 sc1
    v_add_f32 v228, 1.0, v228
    v_add_f32 v229, 1.0, v229
    v_add_f32 v230, 1.0, v230
    v_add_f32 v231, 1.0, v231
    v_mfma_f32_32x32x16_bf16 v[144:159], v[192:195], a[172:175], v[144:159]
    s_waitcnt vmcnt(16)
    ds_read_b128 v[208:211], v3 offset:18592
    v_rcp_f32 v228, v228
    v_rcp_f32 v229, v229
    v_mfma_f32_32x32x16_bf16 v[128:143], v[192:195], a[176:179], v[128:143]
    v_rcp_f32 v230, v230
    v_rcp_f32 v231, v231
    v_mul_f32 v120, v120, v228
    v_mfma_f32_32x32x16_bf16 v[160:175], v[192:195], a[168:171], v[160:175]
    s_waitcnt lgkmcnt(4)
    buffer_load_dwordx4 a[40:43], v4, s[32:35], s69 offen offset:2048 sc1
    v_mul_f32 v121, v121, v229
    v_mul_f32 v122, v122, v230
    v_mul_f32 v123, v123, v231
    v_cvt_pk_bf16_f32 v228, v120, v121
    v_mfma_f32_32x32x16_bf16 v[144:159], v[196:199], a[176:179], v[144:159]
    ds_read_b128 v[212:215], v3 offset:27840
    v_cvt_pk_bf16_f32 v229, v122, v123
    v_and_b32 v217, s47, v236
    v_lshlrev_b32 v218, 16, v237
    v_and_b32 v219, s47, v237
    v_mfma_f32_32x32x16_bf16 v[176:191], v[196:199], a[168:171], v[176:191]
    ds_write_b64 v12, v[228:229] offset:37120
    v_fma_f32 v216, v216, v32, v48
    v_fma_f32 v217, v217, v33, v49
    v_fma_f32 v218, v218, v34, v50
    v_fma_f32 v219, v219, v35, v51
    v_mfma_f32_32x32x16_bf16 v[160:175], v[196:199], a[172:175], v[160:175]
    s_waitcnt lgkmcnt(4)
    buffer_load_dwordx4 a[44:47], v4, s[32:35], s69 offen offset:3072 sc1
    v_exp_f32 v220, v216
    v_exp_f32 v221, v217
    v_mfma_f32_32x32x16_bf16 v[176:191], v[200:203], a[172:175], v[176:191]
    ds_read_b128 v[192:195], v3 offset:96
    v_exp_f32 v222, v218
    v_exp_f32 v223, v219
    v_mfma_f32_32x32x16_bf16 v[160:175], v[200:203], a[176:179], v[160:175]
    s_waitcnt lgkmcnt(4)
    v_add_f32 v220, 1.0, v220
    v_add_f32 v221, 1.0, v221
    v_add_f32 v222, 1.0, v222
    v_add_f32 v223, 1.0, v223
    v_lshlrev_b32 v224, 16, v244
    v_mfma_f32_32x32x16_bf16 v[176:191], v[204:207], a[176:179], v[176:191]
    s_waitcnt vmcnt(17) lgkmcnt(3)
    ds_read_b128 v[196:199], v3 offset:9344
    v_rcp_f32 v220, v220
    v_rcp_f32 v221, v221
    v_mfma_f32_32x32x16_bf16 v[128:143], v[208:211], a[188:191], v[128:143]
    s_waitcnt vmcnt(16)
    ds_read_b128 v[200:203], v3 offset:37088
    v_rcp_f32 v222, v222
    v_rcp_f32 v223, v223
    v_mfma_f32_32x32x16_bf16 v[144:159], v[208:211], a[184:187], v[144:159]
    s_waitcnt vmcnt(15)
    v_mul_f32 v216, v216, v220
    v_mul_f32 v217, v217, v221
    v_mul_f32 v218, v218, v222
    v_mul_f32 v219, v219, v223
    v_cvt_pk_bf16_f32 v220, v216, v217
    v_mfma_f32_32x32x16_bf16 v[160:175], v[208:211], a[180:183], v[160:175]
    s_waitcnt lgkmcnt(4)
    s_mov_b32 s69, 344064
    buffer_load_dwordx4 a[48:51], v4, s[32:35], s69 offen offset:0 sc1
    v_cvt_pk_bf16_f32 v221, v218, v219
    v_and_b32 v225, s47, v244
    v_lshlrev_b32 v226, 16, v245
    v_mfma_f32_32x32x16_bf16 v[144:159], v[212:215], a[188:191], v[144:159]
    ds_read_b128 v[204:207], v3 offset:46336
    ds_write_b64 v13, v[220:221] offset:128
    v_and_b32 v227, s47, v245
    v_fma_f32 v224, v224, v32, v48
    v_fma_f32 v225, v225, v33, v49
    v_mfma_f32_32x32x16_bf16 v[160:175], v[212:215], a[184:187], v[160:175]
    v_fma_f32 v226, v226, v34, v50
    v_fma_f32 v227, v227, v35, v51
    v_exp_f32 v228, v224
    v_lshlrev_b32 v216, 16, v252
    v_mfma_f32_32x32x16_bf16 v[176:191], v[212:215], a[180:183], v[176:191]
    s_waitcnt lgkmcnt(4)
    buffer_load_dwordx4 a[52:55], v4, s[32:35], s69 offen offset:1024 sc1
    v_exp_f32 v229, v225
    v_exp_f32 v230, v226
    v_mfma_f32_32x32x16_bf16 v[128:143], v[192:195], a[180:183], v[128:143]
    s_waitcnt lgkmcnt(3)
    ds_read_b128 v[208:211], v3 offset:368
    v_exp_f32 v231, v227
    v_add_f32 v228, 1.0, v228
    v_add_f32 v229, 1.0, v229
    v_mfma_f32_32x32x16_bf16 v[144:159], v[196:199], a[180:183], v[144:159]
    ds_read_b128 v[212:215], v3 offset:46608
    v_add_f32 v230, 1.0, v230
    v_add_f32 v231, 1.0, v231
    v_rcp_f32 v228, v228
    v_mfma_f32_32x32x16_bf16 v[128:143], v[196:199], a[184:187], v[128:143]
    s_waitcnt lgkmcnt(4)
    buffer_load_dwordx4 a[56:59], v4, s[32:35], s69 offen offset:2048 sc1
    v_rcp_f32 v229, v229
    v_rcp_f32 v230, v230
    v_mfma_f32_32x32x16_bf16 v[176:191], v[200:203], a[184:187], v[176:191]
    ds_read_b128 v[192:195], v3 offset:640
    v_rcp_f32 v231, v231
    v_mul_f32 v224, v224, v228
    v_mul_f32 v225, v225, v229
    v_mfma_f32_32x32x16_bf16 v[160:175], v[200:203], a[188:191], v[160:175]
    s_waitcnt lgkmcnt(4)
    v_mul_f32 v226, v226, v230
    v_mul_f32 v227, v227, v231
    v_cvt_pk_bf16_f32 v228, v224, v225
    v_cvt_pk_bf16_f32 v229, v226, v227
    v_and_b32 v217, s47, v252
    v_mfma_f32_32x32x16_bf16 v[176:191], v[204:207], a[188:191], v[176:191]
    s_waitcnt lgkmcnt(2)
    ds_read_b128 v[196:199], v3 offset:9888
    ds_write_b64 v14, v[228:229] offset:128
    v_lshlrev_b32 v218, 16, v253
    v_and_b32 v219, s47, v253
    v_fma_f32 v216, v216, v32, v48
    v_mfma_f32_32x32x16_bf16 v[128:143], v[208:211], a[192:195], v[128:143]
    s_waitcnt lgkmcnt(3)
    ds_read_b128 v[200:203], v3 offset:19136
    v_fma_f32 v217, v217, v33, v49
    v_fma_f32 v218, v218, v34, v50
    v_fma_f32 v219, v219, v35, v51
    v_mfma_f32_32x32x16_bf16 v[176:191], v[212:215], a[200:203], v[176:191]
    s_waitcnt vmcnt(17) lgkmcnt(3)
    ds_read_b128 v[204:207], v3 offset:28384
    v_exp_f32 v220, v216
    v_exp_f32 v221, v217
    v_exp_f32 v222, v218
    v_exp_f32 v223, v219
    v_add_f32 v220, 1.0, v220
    v_add_f32 v221, 1.0, v221
    v_add_f32 v222, 1.0, v222
    v_add_f32 v223, 1.0, v223
    v_rcp_f32 v220, v220
    v_rcp_f32 v221, v221
    v_rcp_f32 v222, v222
    v_rcp_f32 v223, v223
    v_mul_f32 v216, v216, v220
    v_mul_f32 v217, v217, v221
    v_mul_f32 v218, v218, v222
    v_mul_f32 v219, v219, v223
    v_cvt_pk_bf16_f32 v220, v216, v217
    v_cvt_pk_bf16_f32 v221, v218, v219
    ds_write_b64 v15, v[220:221] offset:128
    v_mfma_f32_32x32x16_bf16 v[128:143], v[192:195], a[204:207], v[128:143]
    s_waitcnt lgkmcnt(4)
    ds_read_b128 v[208:211], v3 offset:37632
    buffer_load_dwordx4 a[60:63], v4, s[32:35], s69 offen offset:3072 sc1
    v_mul_f32 v36, s97, v36
    v_mul_f32 v37, s97, v37
    v_mul_f32 v38, s97, v38
    v_mfma_f32_32x32x16_bf16 v[144:159], v[196:199], a[204:207], v[144:159]
    s_waitcnt vmcnt(17)
    ds_read_b128 v[212:215], v3 offset:46880
    v_mul_f32 v39, s97, v39
    v_fma_f32 v52, -v36, s96, v52
    v_fma_f32 v53, -v37, s96, v53
    v_fma_f32 v54, -v38, s96, v54
    v_mfma_f32_32x32x16_bf16 v[128:143], v[196:199], a[208:211], v[128:143]
    s_waitcnt lgkmcnt(4)
    s_waitcnt lgkmcnt(2)
    s_barrier
    v_fma_f32 v55, -v39, s96, v55
    v_fma_f32 v76, v76, v36, v52
    v_fma_f32 v77, v77, v37, v53
    v_mfma_f32_32x32x16_bf16 v[144:159], v[200:203], a[208:211], v[144:159]
    s_waitcnt vmcnt(16)
    ds_read_b128 v[192:195], v3 offset:128
    s_mov_b32 s69, 348160
    buffer_load_dwordx4 a[64:67], v4, s[32:35], s69 offen offset:0 sc1
    v_fma_f32 v78, v78, v38, v54
    v_fma_f32 v79, v79, v39, v55
    v_mfma_f32_32x32x16_bf16 v[128:143], v[200:203], a[212:215], v[128:143]
    v_exp_f32 v220, v76
    v_exp_f32 v221, v77
    v_add_f32 v220, 1.0, v220
    v_mfma_f32_32x32x16_bf16 v[160:175], v[200:203], a[204:207], v[160:175]
    v_exp_f32 v222, v78
    v_exp_f32 v223, v79
    v_add_f32 v221, 1.0, v221
    v_mfma_f32_32x32x16_bf16 v[144:159], v[204:207], a[212:215], v[144:159]
    ds_read_b128 v[196:199], v3 offset:9376
    buffer_load_dwordx4 a[68:71], v4, s[32:35], s69 offen offset:1024 sc1
    v_add_f32 v222, 1.0, v222
    v_add_f32 v223, 1.0, v223
    v_fma_f32 v92, v92, v36, v52
    v_mfma_f32_32x32x16_bf16 v[176:191], v[204:207], a[204:207], v[176:191]
    v_rcp_f32 v220, v220
    v_rcp_f32 v221, v221
    v_mul_f32 v76, v76, v220
    v_mfma_f32_32x32x16_bf16 v[160:175], v[204:207], a[208:211], v[160:175]
    s_waitcnt lgkmcnt(3)
    v_rcp_f32 v222, v222
    v_rcp_f32 v223, v223
    v_mul_f32 v77, v77, v221
    v_mfma_f32_32x32x16_bf16 v[176:191], v[208:211], a[208:211], v[176:191]
    ds_read_b128 v[200:203], v3 offset:18624
    v_mul_f32 v78, v78, v222
    v_mul_f32 v79, v79, v223
    v_cvt_pk_bf16_f32 v220, v76, v77
    v_cvt_pk_bf16_f32 v221, v78, v79
    v_mfma_f32_32x32x16_bf16 v[160:175], v[208:211], a[212:215], v[160:175]
    s_waitcnt lgkmcnt(3)
    ds_write_b64 v12, v[220:221] offset:9440
    v_fma_f32 v93, v93, v37, v53
    v_fma_f32 v94, v94, v38, v54
    v_fma_f32 v95, v95, v39, v55
    v_fma_f32 v108, v108, v36, v52
    v_mfma_f32_32x32x16_bf16 v[176:191], v[212:215], a[212:215], v[176:191]
    s_waitcnt vmcnt(17) lgkmcnt(3)
    ds_read_b128 v[204:207], v3 offset:27872
    v_exp_f32 v228, v92
    v_exp_f32 v229, v93
    v_mfma_f32_32x32x16_bf16 v[128:143], v[192:195], a[0:3], v[128:143]
    s_waitcnt lgkmcnt(3)
    ds_read_b128 v[208:211], v3 offset:37120
    buffer_load_dwordx4 a[72:75], v4, s[32:35], s69 offen offset:2048 sc1
    v_exp_f32 v230, v94
    v_add_f32 v228, 1.0, v228
    v_mfma_f32_32x32x16_bf16 v[144:159], v[196:199], a[0:3], v[144:159]
    s_waitcnt vmcnt(17)
    ds_read_b128 v[212:215], v3 offset:46368
    v_exp_f32 v231, v95
    v_add_f32 v229, 1.0, v229
    v_add_f32 v230, 1.0, v230
    v_mfma_f32_32x32x16_bf16 v[128:143], v[196:199], a[4:7], v[128:143]
    s_waitcnt lgkmcnt(4)
    v_add_f32 v231, 1.0, v231
    v_rcp_f32 v228, v228
    v_rcp_f32 v229, v229
    v_mfma_f32_32x32x16_bf16 v[144:159], v[200:203], a[4:7], v[144:159]
    s_waitcnt vmcnt(16)
    ds_read_b128 v[192:195], v3 offset:400
    buffer_load_dwordx4 a[76:79], v4, s[32:35], s69 offen offset:3072 sc1
    v_rcp_f32 v230, v230
    v_mul_f32 v92, v92, v228
    v_mfma_f32_32x32x16_bf16 v[128:143], v[200:203], a[8:11], v[128:143]
    v_rcp_f32 v231, v231
    v_mul_f32 v93, v93, v229
    v_mul_f32 v94, v94, v230
    v_mul_f32 v95, v95, v231
    v_mfma_f32_32x32x16_bf16 v[160:175], v[200:203], a[0:3], v[160:175]
    s_waitcnt lgkmcnt(3)
    v_cvt_pk_bf16_f32 v228, v92, v93
    v_cvt_pk_bf16_f32 v229, v94, v95
    v_fma_f32 v109, v109, v37, v53
    v_fma_f32 v110, v110, v38, v54
    v_fma_f32 v111, v111, v39, v55
    v_mfma_f32_32x32x16_bf16 v[144:159], v[204:207], a[8:11], v[144:159]
    ds_read_b128 v[196:199], v3 offset:9648
    s_mov_b32 s69, 352256
    buffer_load_dwordx4 a[80:83], v4, s[32:35], s69 offen offset:0 sc1
    ds_write_b64 v12, v[228:229] offset:18688
    v_fma_f32 v124, v124, v36, v52
    v_mfma_f32_32x32x16_bf16 v[176:191], v[204:207], a[0:3], v[176:191]
    v_exp_f32 v220, v108
    v_exp_f32 v221, v109
    v_add_f32 v220, 1.0, v220
    v_mfma_f32_32x32x16_bf16 v[160:175], v[204:207], a[4:7], v[160:175]
    s_waitcnt lgkmcnt(4)
    v_exp_f32 v222, v110
    v_exp_f32 v223, v111
    v_add_f32 v221, 1.0, v221
    v_mfma_f32_32x32x16_bf16 v[176:191], v[208:211], a[4:7], v[176:191]
    ds_read_b128 v[200:203], v3 offset:18896
    buffer_load_dwordx4 a[84:87], v4, s[32:35], s69 offen offset:1024 sc1
    v_add_f32 v222, 1.0, v222
    v_add_f32 v223, 1.0, v223
    v_fma_f32 v125, v125, v37, v53
    v_mfma_f32_32x32x16_bf16 v[160:175], v[208:211], a[8:11], v[160:175]
    s_waitcnt lgkmcnt(4)
    v_rcp_f32 v220, v220
    v_rcp_f32 v221, v221
    v_mul_f32 v108, v108, v220
    v_mfma_f32_32x32x16_bf16 v[176:191], v[212:215], a[8:11], v[176:191]
    s_waitcnt vmcnt(18) lgkmcnt(3)
    ds_read_b128 v[204:207], v3 offset:28144
    v_rcp_f32 v222, v222
    v_rcp_f32 v223, v223
    v_mfma_f32_32x32x16_bf16 v[128:143], v[192:195], a[12:15], v[128:143]
    s_waitcnt lgkmcnt(3)
    ds_read_b128 v[208:211], v3 offset:37392
    buffer_load_dwordx4 a[88:91], v4, s[32:35], s69 offen offset:2048 sc1
    v_mul_f32 v109, v109, v221
    v_mul_f32 v110, v110, v222
    v_mul_f32 v111, v111, v223
    v_mfma_f32_32x32x16_bf16 v[144:159], v[196:199], a[12:15], v[144:159]
    s_waitcnt vmcnt(18)
    ds_read_b128 v[212:215], v3 offset:46640
    v_cvt_pk_bf16_f32 v220, v108, v109
    v_cvt_pk_bf16_f32 v221, v110, v111
    v_fma_f32 v126, v126, v38, v54
    v_fma_f32 v127, v127, v39, v55
    v_mfma_f32_32x32x16_bf16 v[128:143], v[196:199], a[16:19], v[128:143]
    s_waitcnt lgkmcnt(3)
    ds_write_b64 v12, v[220:221] offset:27936
    v_exp_f32 v228, v124
    v_exp_f32 v229, v125
    v_mfma_f32_32x32x16_bf16 v[144:159], v[200:203], a[16:19], v[144:159]
    s_waitcnt vmcnt(17)
    ds_read_b128 v[192:195], v3 offset:672
    buffer_load_dwordx4 a[92:95], v4, s[32:35], s69 offen offset:3072 sc1
    v_exp_f32 v230, v126
    v_add_f32 v228, 1.0, v228
    v_mfma_f32_32x32x16_bf16 v[128:143], v[200:203], a[20:23], v[128:143]
    v_exp_f32 v231, v127
    v_add_f32 v229, 1.0, v229
    v_add_f32 v230, 1.0, v230
    v_add_f32 v231, 1.0, v231
    v_mfma_f32_32x32x16_bf16 v[160:175], v[200:203], a[12:15], v[160:175]
    s_waitcnt lgkmcnt(4)
    v_rcp_f32 v228, v228
    v_rcp_f32 v229, v229
    v_mul_f32 v124, v124, v228
    v_mfma_f32_32x32x16_bf16 v[144:159], v[204:207], a[20:23], v[144:159]
    ds_read_b128 v[196:199], v3 offset:9920
    s_mov_b32 s69, 356352
    buffer_load_dwordx4 a[96:99], v4, s[32:35], s69 offen offset:0 sc1
    v_rcp_f32 v230, v230
    v_mfma_f32_32x32x16_bf16 v[176:191], v[204:207], a[12:15], v[176:191]
    v_rcp_f32 v231, v231
    v_mul_f32 v125, v125, v229
    v_mul_f32 v126, v126, v230
    v_mul_f32 v127, v127, v231
    v_mfma_f32_32x32x16_bf16 v[160:175], v[204:207], a[16:19], v[160:175]
    s_waitcnt lgkmcnt(4)
    v_cvt_pk_bf16_f32 v228, v124, v125
    v_cvt_pk_bf16_f32 v229, v126, v127
    v_lshlrev_b32 v216, 16, v238
    v_and_b32 v217, s47, v238
    v_lshlrev_b32 v218, 16, v239
    v_mfma_f32_32x32x16_bf16 v[176:191], v[208:211], a[16:19], v[176:191]
    ds_read_b128 v[200:203], v3 offset:19168
    buffer_load_dwordx4 a[100:103], v4, s[32:35], s69 offen offset:1024 sc1
    ds_write_b64 v12, v[228:229] offset:37184
    v_and_b32 v219, s47, v239
    v_fma_f32 v216, v216, v36, v52
    v_mfma_f32_32x32x16_bf16 v[160:175], v[208:211], a[20:23], v[160:175]
    s_waitcnt lgkmcnt(5)
    v_fma_f32 v217, v217, v37, v53
    v_fma_f32 v218, v218, v38, v54
    v_fma_f32 v219, v219, v39, v55
    v_exp_f32 v220, v216
    v_mfma_f32_32x32x16_bf16 v[176:191], v[212:215], a[20:23], v[176:191]
    s_waitcnt vmcnt(19) lgkmcnt(3)
    ds_read_b128 v[204:207], v3 offset:28416
    v_exp_f32 v221, v217
    v_exp_f32 v222, v218
    v_mfma_f32_32x32x16_bf16 v[128:143], v[192:195], a[24:27], v[128:143]
    s_waitcnt lgkmcnt(3)
    ds_read_b128 v[208:211], v3 offset:37664
    buffer_load_dwordx4 a[104:107], v4, s[32:35], s69 offen offset:2048 sc1
    v_exp_f32 v223, v219
    v_add_f32 v220, 1.0, v220
    v_mfma_f32_32x32x16_bf16 v[144:159], v[196:199], a[24:27], v[144:159]
    s_waitcnt vmcnt(19)
    ds_read_b128 v[212:215], v3 offset:46912
    v_add_f32 v221, 1.0, v221
    v_add_f32 v222, 1.0, v222
    v_add_f32 v223, 1.0, v223
    v_lshlrev_b32 v224, 16, v246
    v_mfma_f32_32x32x16_bf16 v[128:143], v[196:199], a[28:31], v[128:143]
    s_waitcnt lgkmcnt(4)
    v_rcp_f32 v220, v220
    v_rcp_f32 v221, v221
    v_mul_f32 v216, v216, v220
    v_mfma_f32_32x32x16_bf16 v[144:159], v[200:203], a[28:31], v[144:159]
    s_waitcnt vmcnt(18)
    ds_read_b128 v[192:195], v3 offset:160
    buffer_load_dwordx4 a[108:111], v4, s[32:35], s69 offen offset:3072 sc1
    v_rcp_f32 v222, v222
    v_mul_f32 v217, v217, v221
    v_mfma_f32_32x32x16_bf16 v[128:143], v[200:203], a[32:35], v[128:143]
    v_rcp_f32 v223, v223
    v_mul_f32 v218, v218, v222
    v_mul_f32 v219, v219, v223
    v_cvt_pk_bf16_f32 v220, v216, v217
    v_mfma_f32_32x32x16_bf16 v[160:175], v[200:203], a[24:27], v[160:175]
    s_waitcnt lgkmcnt(3)
    v_cvt_pk_bf16_f32 v221, v218, v219
    v_and_b32 v225, s47, v246
    v_lshlrev_b32 v226, 16, v247
    v_and_b32 v227, s47, v247
    v_fma_f32 v224, v224, v36, v52
    v_mfma_f32_32x32x16_bf16 v[144:159], v[204:207], a[32:35], v[144:159]
    ds_read_b128 v[196:199], v3 offset:9408
    s_mov_b32 s69, 360448
    buffer_load_dwordx4 a[112:115], v4, s[32:35], s69 offen offset:0 sc1
    ds_write_b64 v13, v[220:221] offset:192
    v_fma_f32 v225, v225, v37, v53
    v_mfma_f32_32x32x16_bf16 v[176:191], v[204:207], a[24:27], v[176:191]
    v_fma_f32 v226, v226, v38, v54
    v_fma_f32 v227, v227, v39, v55
    v_exp_f32 v228, v224
    v_lshlrev_b32 v216, 16, v254
    v_mfma_f32_32x32x16_bf16 v[160:175], v[204:207], a[28:31], v[160:175]
    s_waitcnt lgkmcnt(4)
    v_exp_f32 v229, v225
    v_exp_f32 v230, v226
    v_add_f32 v228, 1.0, v228
    v_mfma_f32_32x32x16_bf16 v[176:191], v[208:211], a[28:31], v[176:191]
    ds_read_b128 v[200:203], v3 offset:18656
    buffer_load_dwordx4 a[116:119], v4, s[32:35], s69 offen offset:1024 sc1
    v_exp_f32 v231, v227
    v_add_f32 v229, 1.0, v229
    v_mfma_f32_32x32x16_bf16 v[160:175], v[208:211], a[32:35], v[160:175]
    s_waitcnt lgkmcnt(4)
    v_add_f32 v230, 1.0, v230
    v_add_f32 v231, 1.0, v231
    v_rcp_f32 v228, v228
    v_and_b32 v217, s47, v254
    v_mfma_f32_32x32x16_bf16 v[176:191], v[212:215], a[32:35], v[176:191]
    s_waitcnt vmcnt(20) lgkmcnt(3)
    ds_read_b128 v[204:207], v3 offset:27904
    v_rcp_f32 v229, v229
    v_rcp_f32 v230, v230
    v_mfma_f32_32x32x16_bf16 v[128:143], v[192:195], a[36:39], v[128:143]
    s_waitcnt lgkmcnt(3)
    ds_read_b128 v[208:211], v3 offset:37152
    buffer_load_dwordx4 a[120:123], v4, s[32:35], s69 offen offset:2048 sc1
    v_rcp_f32 v231, v231
    v_mul_f32 v224, v224, v228
    v_mfma_f32_32x32x16_bf16 v[144:159], v[196:199], a[36:39], v[144:159]
    s_waitcnt vmcnt(20)
    ds_read_b128 v[212:215], v3 offset:46400
    v_mul_f32 v225, v225, v229
    v_mul_f32 v226, v226, v230
    v_mul_f32 v227, v227, v231
    v_cvt_pk_bf16_f32 v228, v224, v225
    v_mfma_f32_32x32x16_bf16 v[128:143], v[196:199], a[40:43], v[128:143]
    s_waitcnt lgkmcnt(3)
    v_cvt_pk_bf16_f32 v229, v226, v227
    v_lshlrev_b32 v218, 16, v255
    v_and_b32 v219, s47, v255
    v_fma_f32 v216, v216, v36, v52
    v_fma_f32 v217, v217, v37, v53
    v_mfma_f32_32x32x16_bf16 v[144:159], v[200:203], a[40:43], v[144:159]
    s_waitcnt vmcnt(19)
    ds_read_b128 v[192:195], v3 offset:432
    buffer_load_dwordx4 a[124:127], v4, s[32:35], s69 offen offset:3072 sc1
    ds_write_b64 v14, v[228:229] offset:192
    v_fma_f32 v218, v218, v38, v54
    v_fma_f32 v219, v219, v39, v55
    v_mfma_f32_32x32x16_bf16 v[128:143], v[200:203], a[44:47], v[128:143]
    v_exp_f32 v220, v216
    v_exp_f32 v221, v217
    v_add_f32 v220, 1.0, v220
    v_mfma_f32_32x32x16_bf16 v[160:175], v[200:203], a[36:39], v[160:175]
    s_waitcnt lgkmcnt(4)
    v_exp_f32 v222, v218
    v_exp_f32 v223, v219
    v_add_f32 v221, 1.0, v221
    v_mfma_f32_32x32x16_bf16 v[144:159], v[204:207], a[44:47], v[144:159]
    ds_read_b128 v[196:199], v3 offset:9680
    s_mov_b32 s69, 364544
    buffer_load_dwordx4 a[128:131], v4, s[32:35], s69 offen offset:0 sc1
    v_add_f32 v222, 1.0, v222
    v_add_f32 v223, 1.0, v223
    v_mfma_f32_32x32x16_bf16 v[176:191], v[204:207], a[36:39], v[176:191]
    v_rcp_f32 v220, v220
    v_rcp_f32 v221, v221
    v_mul_f32 v216, v216, v220
    v_mfma_f32_32x32x16_bf16 v[160:175], v[204:207], a[40:43], v[160:175]
    s_waitcnt lgkmcnt(4)
    v_rcp_f32 v222, v222
    v_rcp_f32 v223, v223
    v_mul_f32 v217, v217, v221
    v_mfma_f32_32x32x16_bf16 v[176:191], v[208:211], a[40:43], v[176:191]
    ds_read_b128 v[200:203], v3 offset:18928
    buffer_load_dwordx4 a[132:135], v4, s[32:35], s69 offen offset:1024 sc1
    v_mul_f32 v218, v218, v222
    v_mul_f32 v219, v219, v223
    v_cvt_pk_bf16_f32 v220, v216, v217
    v_mfma_f32_32x32x16_bf16 v[160:175], v[208:211], a[44:47], v[160:175]
    s_waitcnt lgkmcnt(4)
    v_cvt_pk_bf16_f32 v221, v218, v219
    v_mfma_f32_32x32x16_bf16 v[176:191], v[212:215], a[44:47], v[176:191]
    s_waitcnt vmcnt(21) lgkmcnt(3)
    ds_read_b128 v[204:207], v3 offset:28176
    ds_write_b64 v15, v[220:221] offset:192
    v_mfma_f32_32x32x16_bf16 v[128:143], v[192:195], a[48:51], v[128:143]
    s_waitcnt lgkmcnt(3)
    ds_read_b128 v[208:211], v3 offset:37424
    buffer_load_dwordx4 a[136:139], v4, s[32:35], s69 offen offset:2048 sc1
    v_mfma_f32_32x32x16_bf16 v[144:159], v[196:199], a[48:51], v[144:159]
    s_waitcnt vmcnt(21)
    ds_read_b128 v[212:215], v3 offset:46672
    v_mfma_f32_32x32x16_bf16 v[128:143], v[196:199], a[52:55], v[128:143]
    s_waitcnt lgkmcnt(4)
    v_mfma_f32_32x32x16_bf16 v[144:159], v[200:203], a[52:55], v[144:159]
    s_waitcnt vmcnt(20)
    ds_read_b128 v[192:195], v3 offset:704
    buffer_load_dwordx4 a[140:143], v4, s[32:35], s69 offen offset:3072 sc1
    v_mfma_f32_32x32x16_bf16 v[128:143], v[200:203], a[56:59], v[128:143]
    v_mfma_f32_32x32x16_bf16 v[160:175], v[200:203], a[48:51], v[160:175]
    s_waitcnt lgkmcnt(4)
    v_mfma_f32_32x32x16_bf16 v[144:159], v[204:207], a[56:59], v[144:159]
    ds_read_b128 v[196:199], v3 offset:9952
    v_mfma_f32_32x32x16_bf16 v[176:191], v[204:207], a[48:51], v[176:191]
    v_mfma_f32_32x32x16_bf16 v[160:175], v[204:207], a[52:55], v[160:175]
    s_waitcnt lgkmcnt(3)
    v_mfma_f32_32x32x16_bf16 v[176:191], v[208:211], a[52:55], v[176:191]
    ds_read_b128 v[200:203], v3 offset:19200
    v_mfma_f32_32x32x16_bf16 v[160:175], v[208:211], a[56:59], v[160:175]
    s_waitcnt lgkmcnt(3)
    v_mfma_f32_32x32x16_bf16 v[176:191], v[212:215], a[56:59], v[176:191]
    s_waitcnt vmcnt(20) lgkmcnt(2)
    ds_read_b128 v[204:207], v3 offset:28448
    v_mfma_f32_32x32x16_bf16 v[128:143], v[192:195], a[60:63], v[128:143]
    s_waitcnt lgkmcnt(2)
    ds_read_b128 v[208:211], v3 offset:37696
    v_mfma_f32_32x32x16_bf16 v[144:159], v[196:199], a[60:63], v[144:159]
    s_waitcnt vmcnt(19)
    ds_read_b128 v[212:215], v3 offset:46944
    v_mfma_f32_32x32x16_bf16 v[128:143], v[196:199], a[64:67], v[128:143]
    s_waitcnt lgkmcnt(3)
    s_barrier
    v_mfma_f32_32x32x16_bf16 v[144:159], v[200:203], a[64:67], v[144:159]
    s_waitcnt vmcnt(18)
    ds_read_b128 v[192:195], v3 offset:192
    v_mfma_f32_32x32x16_bf16 v[128:143], v[200:203], a[68:71], v[128:143]
    v_mfma_f32_32x32x16_bf16 v[160:175], v[200:203], a[60:63], v[160:175]
    s_waitcnt lgkmcnt(3)
    v_mfma_f32_32x32x16_bf16 v[144:159], v[204:207], a[68:71], v[144:159]
    ds_read_b128 v[196:199], v3 offset:464
    v_mfma_f32_32x32x16_bf16 v[176:191], v[204:207], a[60:63], v[176:191]
    v_mfma_f32_32x32x16_bf16 v[160:175], v[204:207], a[64:67], v[160:175]
    s_waitcnt lgkmcnt(3)
    v_mfma_f32_32x32x16_bf16 v[176:191], v[208:211], a[64:67], v[176:191]
    ds_read_b128 v[200:203], v3 offset:736
    v_mfma_f32_32x32x16_bf16 v[160:175], v[208:211], a[68:71], v[160:175]
    s_waitcnt lgkmcnt(3)
    v_mfma_f32_32x32x16_bf16 v[176:191], v[212:215], a[68:71], v[176:191]
    s_waitcnt vmcnt(17) lgkmcnt(2)
    ds_read_b128 v[204:207], v3 offset:224
    v_mfma_f32_32x32x16_bf16 v[128:143], v[192:195], a[72:75], v[128:143]
    s_waitcnt vmcnt(14) lgkmcnt(2)
    ds_read_b128 v[208:211], v3 offset:496
    v_mfma_f32_32x32x16_bf16 v[128:143], v[196:199], a[84:87], v[128:143]
    s_waitcnt vmcnt(11) lgkmcnt(2)
    ds_read_b128 v[212:215], v3 offset:768
    v_mfma_f32_32x32x16_bf16 v[128:143], v[200:203], a[96:99], v[128:143]
    s_waitcnt vmcnt(8) lgkmcnt(2)
    ds_read_b128 v[192:195], v3 offset:9440
    v_mfma_f32_32x32x16_bf16 v[128:143], v[204:207], a[108:111], v[128:143]
    s_waitcnt vmcnt(5) lgkmcnt(2)
    ds_read_b128 v[196:199], v3 offset:9712
    v_mfma_f32_32x32x16_bf16 v[128:143], v[208:211], a[120:123], v[128:143]
    s_waitcnt vmcnt(2) lgkmcnt(2)
    ds_read_b128 v[200:203], v3 offset:9984
    v_mfma_f32_32x32x16_bf16 v[128:143], v[212:215], a[132:135], v[128:143]
    s_waitcnt lgkmcnt(2)
    ds_read_b128 v[204:207], v3 offset:9472
    v_mfma_f32_32x32x16_bf16 v[128:143], v[192:195], a[76:79], v[128:143]
    ds_read_b128 v[208:211], v3 offset:9744
    v_mfma_f32_32x32x16_bf16 v[144:159], v[192:195], a[72:75], v[144:159]
    s_waitcnt lgkmcnt(3)
    v_mfma_f32_32x32x16_bf16 v[128:143], v[196:199], a[88:91], v[128:143]
    ds_read_b128 v[212:215], v3 offset:10016
    v_mfma_f32_32x32x16_bf16 v[144:159], v[196:199], a[84:87], v[144:159]
    s_waitcnt lgkmcnt(3)
    v_mfma_f32_32x32x16_bf16 v[128:143], v[200:203], a[100:103], v[128:143]
    ds_read_b128 v[192:195], v3 offset:18688
    v_mfma_f32_32x32x16_bf16 v[144:159], v[200:203], a[96:99], v[144:159]
    s_waitcnt lgkmcnt(3)
    v_mfma_f32_32x32x16_bf16 v[128:143], v[204:207], a[112:115], v[128:143]
    ds_read_b128 v[196:199], v3 offset:18960
    v_mfma_f32_32x32x16_bf16 v[144:159], v[204:207], a[108:111], v[144:159]
    s_waitcnt lgkmcnt(3)
    v_mfma_f32_32x32x16_bf16 v[128:143], v[208:211], a[124:127], v[128:143]
    ds_read_b128 v[200:203], v3 offset:19232
    v_mfma_f32_32x32x16_bf16 v[144:159], v[208:211], a[120:123], v[144:159]
    s_waitcnt vmcnt(1) lgkmcnt(3)
    v_mfma_f32_32x32x16_bf16 v[128:143], v[212:215], a[136:139], v[128:143]
    ds_read_b128 v[204:207], v3 offset:18720
    v_mfma_f32_32x32x16_bf16 v[144:159], v[212:215], a[132:135], v[144:159]
    s_waitcnt lgkmcnt(3)
    v_mfma_f32_32x32x16_bf16 v[128:143], v[192:195], a[80:83], v[128:143]
    ds_read_b128 v[208:211], v3 offset:18992
    v_mfma_f32_32x32x16_bf16 v[144:159], v[192:195], a[76:79], v[144:159]
    v_mfma_f32_32x32x16_bf16 v[160:175], v[192:195], a[72:75], v[160:175]
    s_waitcnt lgkmcnt(3)
    v_mfma_f32_32x32x16_bf16 v[128:143], v[196:199], a[92:95], v[128:143]
    ds_read_b128 v[212:215], v3 offset:19264
    v_mfma_f32_32x32x16_bf16 v[144:159], v[196:199], a[88:91], v[144:159]
    v_mfma_f32_32x32x16_bf16 v[160:175], v[196:199], a[84:87], v[160:175]
    s_waitcnt lgkmcnt(3)
    v_mfma_f32_32x32x16_bf16 v[128:143], v[200:203], a[104:107], v[128:143]
    ds_read_b128 v[192:195], v3 offset:27936
    v_mfma_f32_32x32x16_bf16 v[144:159], v[200:203], a[100:103], v[144:159]
    v_mfma_f32_32x32x16_bf16 v[160:175], v[200:203], a[96:99], v[160:175]
    s_waitcnt lgkmcnt(3)
    v_mfma_f32_32x32x16_bf16 v[128:143], v[204:207], a[116:119], v[128:143]
    ds_read_b128 v[196:199], v3 offset:28208
    v_mfma_f32_32x32x16_bf16 v[144:159], v[204:207], a[112:115], v[144:159]
    v_mfma_f32_32x32x16_bf16 v[160:175], v[204:207], a[108:111], v[160:175]
    s_waitcnt lgkmcnt(3)
    v_mfma_f32_32x32x16_bf16 v[128:143], v[208:211], a[128:131], v[128:143]
    ds_read_b128 v[200:203], v3 offset:28480
    v_mfma_f32_32x32x16_bf16 v[144:159], v[208:211], a[124:127], v[144:159]
    v_mfma_f32_32x32x16_bf16 v[160:175], v[208:211], a[120:123], v[160:175]
    s_waitcnt vmcnt(0) lgkmcnt(3)
    v_mfma_f32_32x32x16_bf16 v[128:143], v[212:215], a[140:143], v[128:143]
    ds_read_b128 v[204:207], v3 offset:27968
    v_mfma_f32_32x32x16_bf16 v[144:159], v[212:215], a[136:139], v[144:159]
    v_mfma_f32_32x32x16_bf16 v[160:175], v[212:215], a[132:135], v[160:175]
    s_waitcnt lgkmcnt(3)
    v_mfma_f32_32x32x16_bf16 v[144:159], v[192:195], a[80:83], v[144:159]
    ds_read_b128 v[208:211], v3 offset:28240
    s_nop 5
    v_mul_f32 v128, s48, v128
    v_mul_f32 v129, s48, v129
    v_mul_f32 v130, s48, v130
    v_mul_f32 v131, s48, v131
    v_mfma_f32_32x32x16_bf16 v[160:175], v[192:195], a[76:79], v[160:175]
    v_mul_f32 v132, s48, v132
    v_mul_f32 v133, s48, v133
    v_mul_f32 v134, s48, v134
    v_mul_f32 v135, s48, v135
    v_mul_f32 v136, s48, v136
    v_mfma_f32_32x32x16_bf16 v[176:191], v[192:195], a[72:75], v[176:191]
    s_waitcnt lgkmcnt(3)
    v_mul_f32 v137, s48, v137
    v_mul_f32 v138, s48, v138
    v_mul_f32 v139, s48, v139
    v_mul_f32 v140, s48, v140
    v_mul_f32 v141, s48, v141
    v_mfma_f32_32x32x16_bf16 v[144:159], v[196:199], a[92:95], v[144:159]
    ds_read_b128 v[212:215], v3 offset:28512
    s_add_u32 s50, s79, 524288
    v_mul_f32 v142, s48, v142
    v_mul_f32 v143, s48, v143
    v_cvt_pk_bf16_f32 v216, v128, v129
    v_cvt_pk_bf16_f32 v217, v130, v131
    v_mfma_f32_32x32x16_bf16 v[160:175], v[196:199], a[88:91], v[160:175]
    v_cvt_pk_bf16_f32 v218, v132, v133
    v_cvt_pk_bf16_f32 v219, v134, v135
    v_cvt_pk_bf16_f32 v220, v136, v137
    v_cvt_pk_bf16_f32 v221, v138, v139
    v_cvt_pk_bf16_f32 v222, v140, v141
    v_mfma_f32_32x32x16_bf16 v[176:191], v[196:199], a[84:87], v[176:191]
    s_waitcnt lgkmcnt(3)
    v_cvt_pk_bf16_f32 v223, v142, v143
    v_permlane32_swap_b32 v216, v218
    v_permlane32_swap_b32 v217, v219
    v_permlane32_swap_b32 v220, v222
    v_permlane32_swap_b32 v221, v223
    v_mfma_f32_32x32x16_bf16 v[144:159], v[200:203], a[104:107], v[144:159]
    ds_read_b128 v[192:195], v3 offset:37184
    v_permlane16_swap_b32 v216, v220
    v_permlane16_swap_b32 v217, v221
    v_permlane16_swap_b32 v218, v222
    v_permlane16_swap_b32 v219, v223
    v_mfma_f32_32x32x16_bf16 v[160:175], v[200:203], a[100:103], v[160:175]
    buffer_store_dwordx4 v[216:219], v17, s[36:39], s79 offen offset:0 sc0 sc1 nt
    buffer_store_dwordx4 v[220:223], v17, s[36:39], s50 offen offset:0 sc0 sc1 nt
    v_mfma_f32_32x32x16_bf16 v[176:191], v[200:203], a[96:99], v[176:191]
    s_waitcnt lgkmcnt(3)
    v_mfma_f32_32x32x16_bf16 v[144:159], v[204:207], a[116:119], v[144:159]
    ds_read_b128 v[196:199], v3 offset:37456
    v_mfma_f32_32x32x16_bf16 v[160:175], v[204:207], a[112:115], v[160:175]
    v_mfma_f32_32x32x16_bf16 v[176:191], v[204:207], a[108:111], v[176:191]
    s_waitcnt lgkmcnt(3)
    v_mfma_f32_32x32x16_bf16 v[144:159], v[208:211], a[128:131], v[144:159]
    ds_read_b128 v[200:203], v3 offset:37728
    v_mfma_f32_32x32x16_bf16 v[160:175], v[208:211], a[124:127], v[160:175]
    v_mfma_f32_32x32x16_bf16 v[176:191], v[208:211], a[120:123], v[176:191]
    s_waitcnt lgkmcnt(3)
    v_mfma_f32_32x32x16_bf16 v[144:159], v[212:215], a[140:143], v[144:159]
    ds_read_b128 v[204:207], v3 offset:37216
    v_mfma_f32_32x32x16_bf16 v[160:175], v[212:215], a[136:139], v[160:175]
    v_mfma_f32_32x32x16_bf16 v[176:191], v[212:215], a[132:135], v[176:191]
    s_waitcnt lgkmcnt(3)
    v_mfma_f32_32x32x16_bf16 v[160:175], v[192:195], a[80:83], v[160:175]
    ds_read_b128 v[208:211], v3 offset:37488
    s_nop 5
    v_mul_f32 v144, s48, v144
    v_mul_f32 v145, s48, v145
    v_mul_f32 v146, s48, v146
    v_mul_f32 v147, s48, v147
    v_mfma_f32_32x32x16_bf16 v[176:191], v[192:195], a[76:79], v[176:191]
    s_waitcnt lgkmcnt(3)
    v_mul_f32 v148, s48, v148
    v_mul_f32 v149, s48, v149
    v_mul_f32 v150, s48, v150
    v_mul_f32 v151, s48, v151
    v_mul_f32 v152, s48, v152
    v_mfma_f32_32x32x16_bf16 v[160:175], v[196:199], a[92:95], v[160:175]
    ds_read_b128 v[212:215], v3 offset:37760
    v_mul_f32 v153, s48, v153
    v_mul_f32 v154, s48, v154
    v_mul_f32 v155, s48, v155
    v_mul_f32 v156, s48, v156
    v_mfma_f32_32x32x16_bf16 v[176:191], v[196:199], a[88:91], v[176:191]
    s_waitcnt lgkmcnt(3)
    s_add_u32 s50, s79, 524288
    v_mul_f32 v157, s48, v157
    v_mul_f32 v158, s48, v158
    v_mul_f32 v159, s48, v159
    v_cvt_pk_bf16_f32 v224, v144, v145
    v_mfma_f32_32x32x16_bf16 v[160:175], v[200:203], a[104:107], v[160:175]
    ds_read_b128 v[192:195], v3 offset:46432
    v_cvt_pk_bf16_f32 v225, v146, v147
    v_cvt_pk_bf16_f32 v226, v148, v149
    v_cvt_pk_bf16_f32 v227, v150, v151
    v_cvt_pk_bf16_f32 v228, v152, v153
    v_mfma_f32_32x32x16_bf16 v[176:191], v[200:203], a[100:103], v[176:191]
    s_waitcnt lgkmcnt(3)
    v_cvt_pk_bf16_f32 v229, v154, v155
    v_cvt_pk_bf16_f32 v230, v156, v157
    v_cvt_pk_bf16_f32 v231, v158, v159
    v_permlane32_swap_b32 v224, v226
    v_permlane32_swap_b32 v225, v227
    v_mfma_f32_32x32x16_bf16 v[160:175], v[204:207], a[116:119], v[160:175]
    ds_read_b128 v[196:199], v3 offset:46704
    v_permlane32_swap_b32 v228, v230
    v_permlane32_swap_b32 v229, v231
    s_nop 0
    v_permlane16_swap_b32 v224, v228
    v_permlane16_swap_b32 v225, v229
    v_mfma_f32_32x32x16_bf16 v[176:191], v[204:207], a[112:115], v[176:191]
    s_waitcnt lgkmcnt(3)
    v_permlane16_swap_b32 v226, v230
    v_permlane16_swap_b32 v227, v231
    v_mfma_f32_32x32x16_bf16 v[160:175], v[208:211], a[128:131], v[160:175]
    ds_read_b128 v[200:203], v3 offset:46976
    buffer_store_dwordx4 v[224:227], v17, s[36:39], s79 offen offset:256 sc0 sc1 nt
    buffer_store_dwordx4 v[228:231], v17, s[36:39], s50 offen offset:256 sc0 sc1 nt
    v_mfma_f32_32x32x16_bf16 v[176:191], v[208:211], a[124:127], v[176:191]
    s_waitcnt lgkmcnt(3)
    v_mfma_f32_32x32x16_bf16 v[160:175], v[212:215], a[140:143], v[160:175]
    ds_read_b128 v[204:207], v3 offset:46464
    v_mfma_f32_32x32x16_bf16 v[176:191], v[212:215], a[136:139], v[176:191]
    s_waitcnt lgkmcnt(3)
    v_mfma_f32_32x32x16_bf16 v[176:191], v[192:195], a[80:83], v[176:191]
    s_waitcnt lgkmcnt(2)
    ds_read_b128 v[208:211], v3 offset:46736
    v_mfma_f32_32x32x16_bf16 v[176:191], v[196:199], a[92:95], v[176:191]
    s_waitcnt lgkmcnt(2)
    ds_read_b128 v[212:215], v3 offset:47008
    s_nop 2
    v_mul_f32 v160, s48, v160
    v_mul_f32 v161, s48, v161
    v_mul_f32 v162, s48, v162
    v_mul_f32 v163, s48, v163
    v_mfma_f32_32x32x16_bf16 v[176:191], v[200:203], a[104:107], v[176:191]
    s_waitcnt lgkmcnt(2)
    v_mul_f32 v164, s48, v164
    v_mul_f32 v165, s48, v165
    v_mul_f32 v166, s48, v166
    v_mul_f32 v167, s48, v167
    v_mul_f32 v168, s48, v168
    v_mfma_f32_32x32x16_bf16 v[176:191], v[204:207], a[116:119], v[176:191]
    s_waitcnt lgkmcnt(1)
    v_mul_f32 v169, s48, v169
    v_mul_f32 v170, s48, v170
    v_mul_f32 v171, s48, v171
    v_mul_f32 v172, s48, v172
    v_mul_f32 v173, s48, v173
    v_mfma_f32_32x32x16_bf16 v[176:191], v[208:211], a[128:131], v[176:191]
    s_waitcnt lgkmcnt(0)
    s_add_u32 s50, s79, 524288
    v_mul_f32 v174, s48, v174
    v_mul_f32 v175, s48, v175
    v_cvt_pk_bf16_f32 v216, v160, v161
    v_cvt_pk_bf16_f32 v217, v162, v163
    v_mfma_f32_32x32x16_bf16 v[176:191], v[212:215], a[140:143], v[176:191]
    v_cvt_pk_bf16_f32 v218, v164, v165
    v_cvt_pk_bf16_f32 v219, v166, v167
    v_cvt_pk_bf16_f32 v220, v168, v169
    v_cvt_pk_bf16_f32 v221, v170, v171
    v_cvt_pk_bf16_f32 v222, v172, v173
    v_cvt_pk_bf16_f32 v223, v174, v175
    v_permlane32_swap_b32 v216, v218
    v_permlane32_swap_b32 v217, v219
    v_permlane32_swap_b32 v220, v222
    v_permlane32_swap_b32 v221, v223
    s_nop 0
    v_permlane16_swap_b32 v216, v220
    v_permlane16_swap_b32 v217, v221
    v_permlane16_swap_b32 v218, v222
    v_permlane16_swap_b32 v219, v223
    buffer_store_dwordx4 v[216:219], v17, s[36:39], s79 offen offset:512 sc0 sc1 nt
    buffer_store_dwordx4 v[220:223], v17, s[36:39], s50 offen offset:512 sc0 sc1 nt
    v_pk_mul_f32 v[176:177], v[176:177], s[48:49]
    v_pk_mul_f32 v[178:179], v[178:179], s[48:49]
    v_pk_mul_f32 v[180:181], v[180:181], s[48:49]
    v_pk_mul_f32 v[182:183], v[182:183], s[48:49]
    v_pk_mul_f32 v[184:185], v[184:185], s[48:49]
    v_pk_mul_f32 v[186:187], v[186:187], s[48:49]
    v_pk_mul_f32 v[188:189], v[188:189], s[48:49]
    v_pk_mul_f32 v[190:191], v[190:191], s[48:49]
    v_cvt_pk_bf16_f32 v224, v176, v177
    v_cvt_pk_bf16_f32 v225, v178, v179
    v_cvt_pk_bf16_f32 v226, v180, v181
    v_cvt_pk_bf16_f32 v227, v182, v183
    v_cvt_pk_bf16_f32 v228, v184, v185
    v_cvt_pk_bf16_f32 v229, v186, v187
    v_cvt_pk_bf16_f32 v230, v188, v189
    v_cvt_pk_bf16_f32 v231, v190, v191
    v_permlane32_swap_b32 v224, v226
    v_permlane32_swap_b32 v225, v227
    v_permlane32_swap_b32 v228, v230
    v_permlane32_swap_b32 v229, v231
    s_nop 0
    v_permlane16_swap_b32 v224, v228
    v_permlane16_swap_b32 v225, v229
    v_permlane16_swap_b32 v226, v230
    v_permlane16_swap_b32 v227, v231
    buffer_store_dwordx4 v[224:227], v17, s[36:39], s79 offen offset:768 sc0 sc1 nt
    s_add_u32 s50, s79, 524288
    buffer_store_dwordx4 v[228:231], v17, s[36:39], s50 offen offset:768 sc0 sc1 nt
    s_or_b32 s50, s2, s40
    s_cmp_lg_u32 s50, 0
    s_cbranch_scc1 L_fin
    v_mov_b32 v20, 0
    s_mov_b64 exec, 1
    global_store_dword v20, v20, s[24:25] offset:192 sc1
    s_mov_b64 exec, -1
L_fin:
    s_endpgm
L_slowE:
    s_mov_b32 s70, 0
L_slowE_l:
    buffer_load_dwordx4 v[170:173], v2, s[32:35], s61 offen sc1
    s_add_u32 s70, s70, 1
    s_waitcnt vmcnt(0)
    v_xor_b32 v170, s60, v170
    v_xor_b32 v171, s60, v171
    v_xor_b32 v172, s60, v172
    v_xor_b32 v173, s60, v173
    v_or3_b32 v170, v170, v171, v172
    v_or_b32 v170, v170, v173
    v_cmp_ne_u32 vcc, 0, v170
    s_nop 1
    s_cbranch_vccz L_slowE_x
    s_cmp_lt_u32 s70, 20000
    s_cbranch_scc1 L_slowE_l
L_slowE_x:
    s_nop 4
    s_branch L_backE
L_slowH:
    s_mov_b32 s70, 0
L_slowH_l:
    s_sleep 2
    buffer_load_dwordx4 v[232:235], v2, s[32:35], s76 offen offset:0 sc1
    buffer_load_dwordx4 v[240:243], v2, s[32:35], s77 offen offset:0 sc1
    buffer_load_dwordx4 v[248:251], v16, s[32:35], s78 offen offset:0 sc1
    buffer_load_dwordx4 v[236:239], v2, s[32:35], s76 offen offset:1024 sc1
    buffer_load_dwordx4 v[244:247], v2, s[32:35], s77 offen offset:1024 sc1
    buffer_load_dwordx4 v[252:255], v16, s[32:35], s78 offen offset:1024 sc1
    s_add_u32 s70, s70, 1
    s_waitcnt vmcnt(0)
    v_max3_u32 v59, v232, v233, v234
    v_max3_u32 v59, v59, v235, v236
    v_max3_u32 v59, v59, v237, v238
    v_max3_u32 v59, v59, v239, v240
    v_max3_u32 v59, v59, v241, v242
    v_max3_u32 v59, v59, v243, v244
    v_max3_u32 v59, v59, v245, v246
    v_max3_u32 v59, v59, v247, v248
    v_max3_u32 v59, v59, v249, v250
    v_max3_u32 v59, v59, v251, v252
    v_max3_u32 v59, v59, v253, v254
    v_max_u32 v59, v59, v255
    v_cmp_eq_u32 vcc, -1, v59
    s_nop 1
    s_cbranch_vccz L_slowH_x
    s_cmp_lt_u32 s70, 20000
    s_cbranch_scc1 L_slowH_l
L_slowH_x:
    s_nop 4
    s_branch L_backH
L_end:
    s_endpgm
.section .rodata,"a"
.p2align 6
.amdhsa_kernel standalone__adm_resblock__diffusion_kernel
  .amdhsa_next_free_vgpr 512
  .amdhsa_next_free_sgpr 102
  .amdhsa_accum_offset 256
  .amdhsa_group_segment_fixed_size 0
  .amdhsa_kernarg_size 96
  .amdhsa_user_sgpr_count 2
  .amdhsa_user_sgpr_kernarg_segment_ptr 1
  .amdhsa_system_sgpr_workgroup_id_x 1
.end_amdhsa_kernel
```
